```python
import torch

def _softmax(x, axis=-1):
    return torch.softmax(x, dim=axis)
def _gelu(x):
    return torch.nn.functional.gelu(x, approximate="tanh")
def _silu(x):
    return torch.nn.functional.silu(x)
def _sigmoid(x):
    return torch.sigmoid(x)
def _layernorm(x, axis=-1, eps=1e-5):
    m = x.mean(dim=axis, keepdim=True)
    v = x.var(dim=axis, keepdim=True, unbiased=False)
    return (x - m) / torch.sqrt(v + eps)
def _scatter_add(tgt, idx, src, axis=0):
    return tgt.clone().index_add_(axis, idx, src)
def _segment_sum(src, seg, n):
    out = torch.zeros((n,) + src.shape[1:], dtype=src.dtype)
    return out.index_add_(0, seg, src)
def _pad(x, pw):
    flat = tuple(v for pair in reversed(pw) for v in pair)
    return torch.nn.functional.pad(x, flat)

kernel_name = 'recurrent_scan__ssm_conv_s4__dense_activation_silu__prompt'

def setup_inputs():

    _w = (lambda a: (lambda t: t.to(torch.bfloat16) if t.is_floating_point() else t)(torch.as_tensor(a)))
    def _A_setup():
        B, L, D, N = 1, 2048, 512, 128
        A_re = -(lambda _x: torch.exp(torch.as_tensor(_x)))((lambda *s: torch.randn(*s, dtype=torch.bfloat16) * 3.2)(D, N))
        A_im = torch.pi * (lambda *s: torch.randn(*s, dtype=torch.bfloat16) * 0.2)(D, N)
        B_re = (lambda *s: torch.randn(*s, dtype=torch.bfloat16) * 0.2)(D, N)
        B_im = (lambda *s: torch.randn(*s, dtype=torch.bfloat16) * 0.2)(D, N)
        C_re = (lambda *s: torch.randn(*s, dtype=torch.bfloat16) * 0.2)(D, N)
        C_im = (lambda *s: torch.randn(*s, dtype=torch.bfloat16) * 0.2)(D, N)
        log_dt = (lambda *s: torch.randn(*s, dtype=torch.bfloat16) * 0.2)(D) * 0.5 - 4.0
        Dskip = (lambda *s: torch.randn(*s, dtype=torch.bfloat16) * 0.2)(D)
        return {
            "u": _w((lambda *s: torch.randn(*s, dtype=torch.bfloat16) * 0.05)(B, L, D)),
            "A_re": _w(A_re),
            "A_im": _w(A_im),
            "B_re": _w(B_re),
            "B_im": _w(B_im),
            "C_re": _w(C_re),
            "C_im": _w(C_im),
            "log_dt": _w(log_dt),
            "Dskip": _w(Dskip),
        }
    _A_in = _A_setup()

    def _B_setup():
        B, S, D, F = 1, 2048, 512, 1792
        return {
            "x": _w((lambda *s: torch.randn(*s, dtype=torch.bfloat16) * 0.05)(B, S, D)),
            "w1": _w((lambda *s: torch.randn(*s, dtype=torch.bfloat16) * 0.8)(D, F) * (D ** -0.5)),
            "w2": _w((lambda *s: torch.randn(*s, dtype=torch.bfloat16) * 0.1)(F, D) * (F ** -0.5)),
        }
    _B_in = _B_setup()

    return {
        "A_u": _A_in["u"],
        "A_A_re": _A_in["A_re"],
        "A_A_im": _A_in["A_im"],
        "A_B_re": _A_in["B_re"],
        "A_B_im": _A_in["B_im"],
        "A_C_re": _A_in["C_re"],
        "A_C_im": _A_in["C_im"],
        "A_log_dt": _A_in["log_dt"],
        "A_Dskip": _A_in["Dskip"],
        "B_x": _B_in["x"],
        "B_w1": _B_in["w1"],
        "B_w2": _B_in["w2"],
    }

def reference(A_u, A_A_re, A_A_im, A_B_re, A_B_im, A_C_re, A_C_im, A_log_dt, A_Dskip, B_x, B_w1, B_w2):
    def _A_ref(u, A_re, A_im, B_re, B_im, C_re, C_im, log_dt, Dskip):
        Bsz, L, D = u.shape
        dt = torch.exp(log_dt)[:, None]
        A = A_re + 1j * A_im
        Bc = B_re + 1j * B_im
        Cc = C_re + 1j * C_im
        logdA = dt * A
        dB = dt * Bc
        l = (lambda x, dt: x.to(dt))(torch.arange(L), A_re.dtype)
        P = torch.exp(logdA[:, :, None] * l[None, None, :])
        K = torch.einsum("dn,dnl,dn->dl", Cc, P, dB).real
        L2 = 2 * L
        Kp = _pad(K, ((0, 0), (0, L)))
        up = (lambda x, *d: x.permute(*d))(u, 0, 2, 1)
        up = _pad(up, ((0, 0), (0, 0), (0, L)))
        Kf = (lambda x, axes=(-2,-1): torch.fft.rfft2(x.float(), dim=axes))(Kp[:, None, :], axes=(-2, -1))
        Uf = (lambda x, axes=(-2,-1): torch.fft.rfft2(x.float(), dim=axes))(up[:, :, None, :], axes=(-2, -1))
        Yf = Uf * Kf[None, :, :, :]
        y = (lambda x, s, axes=(-2,-1): torch.fft.irfft2(x, s=s, dim=axes).to(torch.bfloat16))(Yf, (1, L2), axes=(-2, -1))[:, :, 0, :L]
        y = (lambda x, *d: x.permute(*d))(y, 0, 2, 1) + u * Dskip[None, None, :]
        return y

    def _B_ref(x, w1, w2):
        h = torch.einsum("bsd,df->bsf", x, w1)
        h = _silu(h)
        out = torch.einsum("bsf,fd->bsd", h, w2)
        return out

    x = A_u
    xn = _layernorm(x, axis=-1)
    s = _A_ref(xn, A_A_re, A_A_im, A_B_re, A_B_im, A_C_re, A_C_im, A_log_dt, A_Dskip)
    g = _silu(_B_ref(xn, B_w1, B_w2))
    return x + s * g
```

```asm
; @launch grid=(256,1,1) block=(512,1,1) lds=163840
.amdgcn_target "amdgcn-amd-amdhsa--gfx950"
.text
.set CODE_LINES, (L_end - L_pc0) / 128
.globl recurrent_scan__ssm_conv_s4__dense_activation_silu__prompt_kernel
.p2align 8
.type recurrent_scan__ssm_conv_s4__dense_activation_silu__prompt_kernel,@function
recurrent_scan__ssm_conv_s4__dense_activation_silu__prompt_kernel:
    s_cmp_ge_u32 s2, 256
    s_cbranch_scc1 L_end
    s_load_dwordx16 s[8:23], s[0:1], 0
    v_lshrrev_b32 v2, 6, v0
    s_nop 0
    v_readfirstlane_b32 s3, v2
    s_nop 0
    s_cmp_lg_u32 s3, 3
    s_cbranch_scc1 L_cpf_1
    s_getpc_b64 s[4:5]
L_pc0:
    s_lshr_b32 s3, s2, 3
    s_mul_i32 s3, s3, 14
    v_and_b32 v2, 63, v0
    v_min_u32 v2, 13, v2
    v_add_u32 v2, s3, v2
    v_min_u32 v2, CODE_LINES, v2
    v_lshlrev_b32 v2, 7, v2
    v_mov_b32 v3, s5
    v_add_co_u32 v2, vcc, s4, v2
    s_nop 1
    v_addc_co_u32 v3, vcc, 0, v3, vcc
    global_load_dword v233, v[2:3], off
L_cpf_1:
    s_load_dwordx8 s[24:31], s[0:1], 64
    s_load_dwordx4 s[32:35], s[0:1], 96
    s_load_dwordx2 s[36:37], s[0:1], 112
    s_mov_b32 s60, s2
    v_lshrrev_b32 v2, 6, v0
    v_and_b32 v1, 63, v0
    v_readfirstlane_b32 s61, v2
    s_and_b32 s62, s2, 7
    s_lshr_b32 s63, s2, 3
    s_sub_u32 s71, s63, 4
    s_max_i32 s71, s71, 0
    s_mul_i32 s68, s71, 37
    s_lshr_b32 s68, s68, 8
    s_mul_i32 s69, s68, 7
    s_sub_u32 s69, s71, s69
    s_lshr_b32 s70, s62, 1
    s_lshl_b32 s70, s70, 2
    s_add_u32 s64, s70, s68
    s_and_b32 s70, s62, 1
    s_mul_i32 s70, s70, 7
    s_add_u32 s65, s70, s69
    s_lshl_b32 s68, s68, 2
    s_lshl_b32 s69, s69, 1
    s_add_u32 s66, s68, s69
    s_lshr_b32 s68, s62, 1
    s_add_u32 s66, s66, s68
    s_and_b32 s66, s66, 15
    s_lshr_b32 s68, s63, 3
    s_lshl_b32 s84, s62, 2
    s_add_u32 s84, s84, s68
    s_and_b32 s85, s63, 7
    s_cmp_ge_u32 s60, 32
    s_cbranch_scc1 L_map_2
    s_lshl_b32 s64, s62, 2
    s_add_u32 s64, s64, s63
    s_lshr_b32 s68, s62, 1
    s_lshl_b32 s68, s68, 2
    s_add_u32 s66, s68, s63
    s_and_b32 s68, s62, 1
    s_mul_i32 s68, s68, 14
    s_add_u32 s65, s68, s66
L_map_2:
    s_mov_b32 s67, 0
    s_waitcnt lgkmcnt(0)
    s_cmp_lt_u32 s61, 4
    s_cbranch_scc1 L_par_3
    s_sub_u32 s101, s61, 4
    s_lshr_b32 s68, s101, 1
    s_lshl_b32 s69, s60, 1
    s_add_u32 s69, s69, s68
    s_lshl_b32 s69, s69, 8
    s_and_b32 s70, s101, 1
    s_lshl_b32 s70, s70, 7
    s_add_u32 s69, s69, s70
    v_lshlrev_b32 v8, 1, v1
    v_add_u32 v8, s69, v8
    global_load_ushort v10, v8, s[10:11]
    global_load_ushort v11, v8, s[12:13]
    global_load_ushort v12, v8, s[14:15]
    global_load_ushort v13, v8, s[16:17]
    global_load_ushort v14, v8, s[18:19]
    global_load_ushort v15, v8, s[20:21]
    s_lshl_b32 s71, s60, 1
    s_add_u32 s71, s71, s68
    s_lshl_b32 s71, s71, 1
    v_mov_b32 v9, s71
    global_load_ushort v19, v9, s[22:23]
L_par_3:
    s_lshl_b32 s68, s60, 2
    v_mov_b32 v7, s68
    global_load_dword v249, v7, s[24:25]
    s_mov_b32 s40, s8
    s_and_b32 s41, s9, 0xffff
    s_mov_b32 s42, 0x200000
    s_mov_b32 s43, 0x20000
    s_mov_b32 s44, s28
    s_and_b32 s45, s29, 0xffff
    s_mov_b32 s46, 0x1c0000
    s_mov_b32 s47, 0x20000
    s_mov_b32 s52, s36
    s_and_b32 s53, s37, 0xffff
    s_mov_b32 s54, 0xb50000
    s_mov_b32 s55, 0x20000
    s_mov_b32 s48, s30
    s_and_b32 s49, s31, 0xffff
    s_mov_b32 s50, 0x1c0000
    s_mov_b32 s51, 0x20000
    s_mov_b32 s56, s32
    s_and_b32 s57, s33, 0xffff
    s_mov_b32 s58, 0x200000
    s_mov_b32 s59, 0x20000
    v_lshrrev_b32 v4, 3, v1
    v_and_b32 v5, 7, v1
    v_bfe_u32 v6, v1, 4, 1
    v_lshlrev_b32 v6, 2, v6
    v_xor_b32 v5, v5, v6
    v_lshlrev_b32 v5, 4, v5
    v_lshl_add_u32 v243, v4, 10, v5
    v_mov_b32 v2, 0
    v_mov_b32 v3, 0
    v_mov_b32 v4, 0
    v_mov_b32 v5, 0
    s_mul_i32 s2, s85, 7
    s_lshr_b32 s2, s2, 1
    s_and_b32 s68, s84, 3
    s_mul_i32 s68, s68, 7
    s_add_u32 s2, s2, s68
    s_cmp_ge_u32 s2, 28
    s_cselect_b32 s68, 28, 0
    s_sub_u32 s2, s2, s68
    s_or_b32 s68, s60, s61
    s_cmp_lg_u32 s68, 0
    s_cbranch_scc1 L_non_4
    s_memrealtime s[70:71]
    s_waitcnt lgkmcnt(0)
    s_or_b32 s70, s70, 1
    v_mov_b32 v2, s70
    v_mov_b32 v3, 0
    s_mov_b64 exec, 1
    global_store_dword v3, v2, s[34:35] sc1
    s_mov_b64 exec, -1
L_non_4:
    s_cmp_ge_u32 s61, 4
    s_cbranch_scc1 L_common
    s_cmp_lt_u32 s60, 32
    s_cbranch_scc1 L_LNe
    s_setprio 2
    s_lshr_b32 s86, s61, 1
    s_and_b32 s87, s61, 1
    v_lshrrev_b32 v10, 2, v1
    v_and_b32 v11, 3, v1
    v_lshrrev_b32 v12, 2, v10
    v_and_b32 v12, 3, v12
    v_xor_b32 v11, v11, v12
    v_lshlrev_b32 v11, 4, v11
    s_lshl_b32 s68, s61, 5
    v_add_u32 v10, s68, v10
    v_lshl_add_u32 v2, v10, 10, v11
    v_add_u32 v3, 16384, v2
    v_lshrrev_b32 v10, 4, v1
    v_and_b32 v11, 15, v1
    v_lshlrev_b32 v12, 2, v10
    v_xor_b32 v11, v11, v12
    v_lshlrev_b32 v11, 4, v11
    s_lshl_b32 s68, s61, 3
    v_add_u32 v10, s68, v10
    v_mul_u32_u24 v10, 3584, v10
    v_add_u32 v4, v10, v11
    v_add_u32 v5, 14336, v4
    s_lshl_b32 s77, s64, 17
    s_lshl_b32 s78, s65, 8
    s_lshl_b32 s79, s61, 11
    s_mov_b32 s76, s66
    s_lshl_b32 s80, s76, 6
    s_mul_i32 s81, s76, 114688
    s_add_u32 s80, s80, s77
    s_add_u32 m0, s79, 0
    s_add_u32 s81, s81, s78
    buffer_load_dwordx4 v2, s[40:43], s80 offen lds
    s_add_u32 m0, m0, 1024
    s_add_u32 s76, s76, 1
    buffer_load_dwordx4 v3, s[40:43], s80 offen lds
    s_add_u32 m0, m0, 7168
    s_and_b32 s76, s76, 15
    buffer_load_dwordx4 v4, s[44:47], s81 offen lds
    s_add_u32 m0, m0, 1024
    s_nop 0
    buffer_load_dwordx4 v5, s[44:47], s81 offen lds
    s_lshl_b32 s80, s76, 6
    s_mul_i32 s81, s76, 114688
    s_add_u32 s80, s80, s77
    s_add_u32 m0, s79, 16384
    s_add_u32 s81, s81, s78
    buffer_load_dwordx4 v2, s[40:43], s80 offen lds
    s_add_u32 m0, m0, 1024
    s_add_u32 s76, s76, 1
    buffer_load_dwordx4 v3, s[40:43], s80 offen lds
    s_add_u32 m0, m0, 7168
    s_and_b32 s76, s76, 15
    buffer_load_dwordx4 v4, s[44:47], s81 offen lds
    s_add_u32 m0, m0, 1024
    s_nop 0
    buffer_load_dwordx4 v5, s[44:47], s81 offen lds
    s_lshl_b32 s80, s76, 6
    s_mul_i32 s81, s76, 114688
    s_add_u32 s80, s80, s77
    s_add_u32 m0, s79, 32768
    s_add_u32 s81, s81, s78
    buffer_load_dwordx4 v2, s[40:43], s80 offen lds
    s_add_u32 m0, m0, 1024
    s_add_u32 s76, s76, 1
    buffer_load_dwordx4 v3, s[40:43], s80 offen lds
    s_add_u32 m0, m0, 7168
    s_and_b32 s76, s76, 15
    buffer_load_dwordx4 v4, s[44:47], s81 offen lds
    s_add_u32 m0, m0, 1024
    s_nop 0
    buffer_load_dwordx4 v5, s[44:47], s81 offen lds
    s_branch L_common
L_LNe:
    s_setprio 2
    v_lshlrev_b32 v2, 4, v1
    s_lshl_b32 s68, s64, 16
    s_lshl_b32 s69, s61, 14
    s_add_u32 s68, s68, s69
    s_mul_i32 s69, s61, 17024
    s_add_u32 m0, s69, 0
    s_nop 0
    buffer_load_dwordx4 v2, s[40:43], s68 offen lds
    s_add_u32 s68, s68, 1024
    s_add_u32 m0, s69, 1056
    s_nop 0
    buffer_load_dwordx4 v2, s[40:43], s68 offen lds
    s_add_u32 s68, s68, 1024
    s_add_u32 m0, s69, 2112
    s_nop 0
    buffer_load_dwordx4 v2, s[40:43], s68 offen lds
    s_add_u32 s68, s68, 1024
    s_add_u32 m0, s69, 3168
    s_nop 0
    buffer_load_dwordx4 v2, s[40:43], s68 offen lds
    s_add_u32 s68, s68, 1024
    s_add_u32 m0, s69, 4224
    s_nop 0
    buffer_load_dwordx4 v2, s[40:43], s68 offen lds
    s_add_u32 s68, s68, 1024
    s_add_u32 m0, s69, 5280
    s_nop 0
    buffer_load_dwordx4 v2, s[40:43], s68 offen lds
    s_add_u32 s68, s68, 1024
    s_add_u32 m0, s69, 6336
    s_nop 0
    buffer_load_dwordx4 v2, s[40:43], s68 offen lds
    s_add_u32 s68, s68, 1024
    s_add_u32 m0, s69, 7392
    s_nop 0
    buffer_load_dwordx4 v2, s[40:43], s68 offen lds
    s_add_u32 s68, s68, 1024
    s_add_u32 m0, s69, 8576
    s_nop 0
    buffer_load_dwordx4 v2, s[40:43], s68 offen lds
    s_add_u32 s68, s68, 1024
    s_add_u32 m0, s69, 9632
    s_nop 0
    buffer_load_dwordx4 v2, s[40:43], s68 offen lds
    s_add_u32 s68, s68, 1024
    s_add_u32 m0, s69, 10688
    s_nop 0
    buffer_load_dwordx4 v2, s[40:43], s68 offen lds
    s_add_u32 s68, s68, 1024
    s_add_u32 m0, s69, 11744
    s_nop 0
    buffer_load_dwordx4 v2, s[40:43], s68 offen lds
    s_add_u32 s68, s68, 1024
    s_add_u32 m0, s69, 12800
    s_nop 0
    buffer_load_dwordx4 v2, s[40:43], s68 offen lds
    s_add_u32 s68, s68, 1024
    s_add_u32 m0, s69, 13856
    s_nop 0
    buffer_load_dwordx4 v2, s[40:43], s68 offen lds
    s_add_u32 s68, s68, 1024
    s_add_u32 m0, s69, 14912
    s_nop 0
    buffer_load_dwordx4 v2, s[40:43], s68 offen lds
    s_add_u32 s68, s68, 1024
    s_add_u32 m0, s69, 15968
    s_nop 0
    buffer_load_dwordx4 v2, s[40:43], s68 offen lds
    v_mov_b32 v151, 0
    global_load_dword v150, v151, s[34:35] sc1
L_common:
    s_mul_i32 s2, s85, 7
    s_lshr_b32 s2, s2, 1
    s_and_b32 s68, s84, 3
    s_mul_i32 s68, s68, 7
    s_add_u32 s2, s2, s68
    s_cmp_ge_u32 s2, 28
    s_cselect_b32 s68, 28, 0
    s_sub_u32 s2, s2, s68
    v_lshrrev_b32 v30, 5, v1
    v_bfe_u32 v31, v1, 2, 2
    v_lshl_add_u32 v30, v30, 3, v31
    v_lshlrev_b32 v30, 7, v30
    v_bfe_u32 v32, v1, 4, 1
    v_lshl_add_u32 v30, v32, 5, v30
    v_and_b32 v32, 3, v1
    v_lshl_add_u32 v30, v32, 3, v30
    s_and_b32 s68, s61, 3
    s_mul_i32 s68, s68, 28672
    v_add_u32 v30, s68, v30
    v_lshrrev_b32 v31, 1, v31
    v_lshl_add_u32 v240, v31, 6, v30
    v_xor_b32 v31, 1, v31
    v_lshl_add_u32 v241, v31, 6, v30
    v_lshrrev_b32 v30, 5, v1
    v_and_b32 v31, 31, v1
    v_lshlrev_b32 v31, 4, v31
    v_lshl_add_u32 v30, v30, 10, v31
    s_lshr_b32 s68, s61, 2
    s_lshl_b32 s68, s68, 9
    v_add_u32 v242, s68, v30
    v_and_b32 v30, 31, v1
    v_lshrrev_b32 v31, 5, v1
    s_lshr_b32 s68, s61, 2
    s_and_b32 s69, s61, 3
    s_lshl_b32 s70, s84, 6
    s_lshl_b32 s71, s68, 5
    s_add_u32 s70, s70, s71
    v_add_u32 v32, s70, v30
    v_lshlrev_b32 v244, 10, v32
    v_lshl_add_u32 v244, v31, 3, v244
    s_lshl_b32 s72, s85, 7
    s_lshl_b32 s73, s69, 4
    s_add_u32 s38, s72, s73
    v_lshlrev_b32 v245, 2, v32
    v_lshl_add_u32 v245, v31, 14, v245
    s_lshl_b32 s72, s85, 18
    s_lshl_b32 s73, s69, 15
    s_add_u32 s39, s72, s73
    s_add_u32 s39, s39, 9437184
    s_lshl_b32 s72, s85, 12
    s_lshr_b32 s73, s84, 2
    s_lshl_b32 s73, s73, 2
    s_add_u32 s72, s72, s73
    s_add_u32 s72, s72, 11698176
    v_lshlrev_b32 v248, 7, v30
    v_add_u32 v248, s72, v248
    s_and_b32 s68, s61, 3
    s_mul_i32 s68, s68, 7
    s_lshr_b32 s68, s68, 1
    s_lshr_b32 s69, s84, 1
    s_and_b32 s70, s84, 1
    v_bfe_u32 v30, v1, 1, 2
    v_add_u32 v30, s68, v30
    v_cmp_le_u32 vcc, 7, v30
    s_nop 1
    v_cndmask_b32 v31, 0, 1, vcc
    v_mul_u32_u24 v32, 7, v31
    v_sub_u32 v30, v30, v32
    s_and_b32 s71, s69, 3
    s_mul_i32 s71, s71, 7
    s_add_u32 s71, s71, 4
    v_add_u32 v30, s71, v30
    s_lshr_b32 s71, s69, 2
    s_lshl_b32 s71, s71, 1
    v_add_u32 v31, s71, v31
    v_lshl_add_u32 v30, v30, 3, v31
    v_lshlrev_b32 v30, 7, v30
    v_and_b32 v31, 1, v1
    s_lshl_b32 s70, s70, 1
    v_add_u32 v31, s70, v31
    v_lshl_add_u32 v30, v31, 2, v30
    v_add_u32 v252, 11665408, v30
    v_and_b32 v30, 15, v1
    v_lshrrev_b32 v31, 4, v1
    v_and_b32 v32, 1, v30
    s_lshr_b32 s68, s61, 2
    s_and_b32 s69, s61, 1
    s_mul_i32 s70, s68, 8448
    s_lshl_b32 s71, s69, 8
    s_sub_u32 s70, s70, s71
    s_add_u32 s70, s70, 114744
    v_mul_u32_u24 v33, 4228, v32
    v_lshlrev_b32 v34, 2, v30
    v_sub_u32 v33, v33, v34
    v_lshl_add_u32 v33, v31, 4, v33
    v_add_u32 v246, s70, v33
    s_mul_i32 s70, s68, 11520
    s_mul_i32 s71, s69, 640
    s_sub_u32 s70, s70, s71
    s_add_u32 s70, s70, 131584
    v_mul_u32_u24 v33, 72, v32
    v_lshrrev_b32 v34, 1, v30
    v_mul_u32_u24 v34, 160, v34
    v_add_u32 v33, v33, v34
    v_lshl_add_u32 v33, v31, 4, v33
    v_add_u32 v247, s70, v33
    s_lshr_b32 s68, s61, 2
    s_lshl_b32 s68, s68, 1
    s_and_b32 s69, s61, 1
    s_add_u32 s68, s68, s69
    s_mov_b32 s72, 0x07040300
    s_mov_b32 s73, 0x06050201
    s_bitcmp1_b32 s61, 1
    s_cselect_b32 s72, s73, s72
    s_lshl_b32 s73, s68, 3
    s_lshr_b32 s72, s72, s73
    s_and_b32 s26, s72, 0xff
    s_lshl_b32 s69, s61, 12
    s_add_u32 s69, s69, 131584
    s_cmp_eq_u32 s61, 7
    s_cselect_b32 s69, 114688, s69
    v_lshlrev_b32 v30, 4, v1
    v_add_u32 v250, s69, v30
    s_and_b32 s70, s61, 2
    s_lshl_b32 s70, s70, 12
    s_lshl_b32 s71, s68, 10
    s_add_u32 s70, s70, s71
    s_add_u32 s70, s70, 131584
    v_add_u32 v251, s70, v30
    s_add_u32 s70, s70, 20480
    s_add_u32 s71, s71, 114688
    s_bitcmp1_b32 s61, 1
    s_cselect_b32 s70, s71, s70
    v_add_u32 v255, s70, v30
    v_and_b32 v30, 1, v1
    v_lshrrev_b32 v31, 4, v1
    v_lshlrev_b32 v31, 3, v31
    v_bfe_u32 v32, v1, 1, 3
    v_lshl_add_u32 v31, v32, 5, v31
    v_lshl_add_u32 v31, v30, 2, v31
    s_lshl_b32 s73, s26, 8
    v_add_u32 v31, s73, v31
    v_lshlrev_b32 v253, 2, v31
    v_sub_u32 v32, 2044, v31
    v_lshlrev_b32 v32, 1, v32
    v_add_u32 v254, 118912, v32
    s_cmp_lt_u32 s61, 4
    s_cbranch_scc1 L_M
    s_cmp_lt_u32 s60, 32
    s_cbranch_scc1 L_HLN
    v_and_b32 v2, 255, v0
    v_mov_b32 v4, 0
    v_mov_b32 v5, 0
    v_mov_b32 v6, 0
    v_mov_b32 v7, 0
    s_mov_b64 s[82:83], exec
    s_lshr_b32 s71, s101, 1
    s_mul_i32 s71, s71, 11520
    s_and_b32 s72, s101, 1
    s_mul_i32 s72, s72, 640
    s_add_u32 s71, s71, s72
    s_add_u32 s71, s71, 131584
    v_lshlrev_b32 v3, 3, v1
    v_add_u32 v3, s71, v3
    ds_write_b64 v3, v[4:5]
    s_mov_b64 exec, 0xffff
    ds_write_b64 v3, v[4:5] offset:512
    s_mov_b64 exec, -1
    v_and_b32 v9, 15, v1
    v_lshlrev_b32 v16, 3, v9
    v_cvt_f32_u32 v20, v16
    v_and_b32 v16, 7, v9
    v_lshrrev_b32 v17, 3, v9
    v_lshl_add_u32 v16, v17, 7, v16
    v_cvt_f32_u32 v22, v16
    v_and_b32 v16, 3, v9
    v_lshlrev_b32 v16, 1, v16
    v_bfe_u32 v17, v9, 2, 1
    v_lshl_add_u32 v16, v17, 7, v16
    v_add_u32 v16, 256, v16
    v_and_b32 v17, 1, v9
    v_lshlrev_b32 v17, 2, v17
    v_bfe_u32 v18, v9, 1, 2
    v_lshl_add_u32 v17, v18, 7, v17
    v_add_u32 v17, 512, v17
    v_cmp_gt_u32 vcc, 8, v9
    s_nop 1
    v_cndmask_b32 v16, v17, v16, vcc
    v_cvt_f32_u32 v24, v16
    v_lshlrev_b32 v16, 7, v9
    v_add_u32 v16, 1024, v16
    v_cvt_f32_u32 v26, v16
    s_lshl_b32 s74, s101, 2
    s_add_u32 s74, s74, 160832
    v_mov_b32 v122, s74
    v_mov_b32 v123, 0
    ds_write_b32 v122, v123
    s_lshr_b32 s68, s101, 1
    s_waitcnt vmcnt(1)
    v_lshlrev_b32 v16, 16, v19
    v_mul_f32 v16, 0x3fb8aa3b, v16
    v_exp_f32 v16, v16
    s_nop 0
    v_cvt_pk_bf16_f32 v16, v16, v16
    v_lshlrev_b32 v16, 16, v16
    v_lshlrev_b32 v10, 16, v10
    v_lshlrev_b32 v11, 16, v11
    v_lshlrev_b32 v12, 16, v12
    v_lshlrev_b32 v13, 16, v13
    v_lshlrev_b32 v14, 16, v14
    v_lshlrev_b32 v15, 16, v15
    v_mul_f32 v104, v16, v10
    v_mul_f32 v104, 0x3fb8aa3b, v104
    v_mul_f32 v105, v16, v11
    v_mul_f32 v105, 0x3e22f983, v105
    v_rndne_f32 v108, v105
    v_sub_f32 v105, v105, v108
    v_mul_f32 v12, v16, v12
    v_mul_f32 v13, v16, v13
    v_mul_f32 v106, v14, v12
    v_fma_f32 v106, -v15, v13, v106
    v_mul_f32 v107, v14, v13
    v_fma_f32 v107, v15, v12, v107
    s_lshl_b32 s69, s101, 10
    s_add_u32 s69, s69, 133632
    v_lshlrev_b32 v3, 4, v1
    v_add_u32 v3, s69, v3
    ds_write_b128 v3, v[104:107]
    v_lshrrev_b32 v3, 4, v1
    v_lshlrev_b32 v3, 8, v3
    v_add_u32 v28, s69, v3
    ds_read_b128 v[48:51], v28
    s_waitcnt lgkmcnt(0)
    ds_read_b128 v[52:55], v28 offset:16
    v_mul_f32 v73, v49, v20
    v_mul_f32 v75, v49, v22
    v_mul_f32 v77, v49, v24
    v_mul_f32 v79, v49, v26
    v_mul_f32 v72, v48, v20
    v_mul_f32 v74, v48, v22
    v_mul_f32 v76, v48, v24
    v_mul_f32 v78, v48, v26
    v_fract_f32 v77, v77
    v_fract_f32 v79, v79
    v_cos_f32 v88, v73
    v_cos_f32 v90, v75
    v_cos_f32 v92, v77
    v_cos_f32 v94, v79
    v_sin_f32 v89, v73
    v_sin_f32 v91, v75
    v_sin_f32 v93, v77
    v_sin_f32 v95, v79
    v_exp_f32 v80, v72
    v_exp_f32 v82, v74
    v_exp_f32 v84, v76
    v_exp_f32 v86, v78
    v_mul_f32 v96, v50, v88
    v_mul_f32 v97, v50, v89
    v_fma_f32 v96, -v51, v89, v96
    v_fma_f32 v97, -v51, v88, -v97
    v_mul_f32 v90, v90, v82
    v_mul_f32 v91, v91, v82
    v_mul_f32 v92, v92, v84
    v_mul_f32 v93, v93, v84
    v_mul_f32 v94, v94, v86
    v_mul_f32 v95, v95, v86
    v_mul_f32 v96, v96, v80
    v_mul_f32 v97, v97, v80
    v_cvt_pk_bf16_f32 v128, v90, v91
    v_cvt_pk_bf16_f32 v132, v92, v93
    v_cvt_pk_bf16_f32 v136, v94, v95
    v_cvt_pk_bf16_f32 v140, v96, v97
    s_waitcnt lgkmcnt(0)
    ds_read_b128 v[48:51], v28 offset:32
    v_mul_f32 v73, v53, v20
    v_mul_f32 v75, v53, v22
    v_mul_f32 v77, v53, v24
    v_mul_f32 v79, v53, v26
    v_mul_f32 v72, v52, v20
    v_mul_f32 v74, v52, v22
    v_mul_f32 v76, v52, v24
    v_mul_f32 v78, v52, v26
    v_fract_f32 v77, v77
    v_fract_f32 v79, v79
    v_cos_f32 v88, v73
    v_cos_f32 v90, v75
    v_cos_f32 v92, v77
    v_cos_f32 v94, v79
    v_sin_f32 v89, v73
    v_sin_f32 v91, v75
    v_sin_f32 v93, v77
    v_sin_f32 v95, v79
    v_exp_f32 v80, v72
    v_exp_f32 v82, v74
    v_exp_f32 v84, v76
    v_exp_f32 v86, v78
    v_mul_f32 v96, v54, v88
    v_mul_f32 v97, v54, v89
    v_fma_f32 v96, -v55, v89, v96
    v_fma_f32 v97, -v55, v88, -v97
    v_mul_f32 v90, v90, v82
    v_mul_f32 v91, v91, v82
    v_mul_f32 v92, v92, v84
    v_mul_f32 v93, v93, v84
    v_mul_f32 v94, v94, v86
    v_mul_f32 v95, v95, v86
    v_mul_f32 v96, v96, v80
    v_mul_f32 v97, v97, v80
    v_cvt_pk_bf16_f32 v129, v90, v91
    v_cvt_pk_bf16_f32 v133, v92, v93
    v_cvt_pk_bf16_f32 v137, v94, v95
    v_cvt_pk_bf16_f32 v141, v96, v97
    s_waitcnt lgkmcnt(0)
    ds_read_b128 v[52:55], v28 offset:48
    v_mul_f32 v73, v49, v20
    v_mul_f32 v75, v49, v22
    v_mul_f32 v77, v49, v24
    v_mul_f32 v79, v49, v26
    v_mul_f32 v72, v48, v20
    v_mul_f32 v74, v48, v22
    v_mul_f32 v76, v48, v24
    v_mul_f32 v78, v48, v26
    v_fract_f32 v77, v77
    v_fract_f32 v79, v79
    v_cos_f32 v88, v73
    v_cos_f32 v90, v75
    v_cos_f32 v92, v77
    v_cos_f32 v94, v79
    v_sin_f32 v89, v73
    v_sin_f32 v91, v75
    v_sin_f32 v93, v77
    v_sin_f32 v95, v79
    v_exp_f32 v80, v72
    v_exp_f32 v82, v74
    v_exp_f32 v84, v76
    v_exp_f32 v86, v78
    v_mul_f32 v96, v50, v88
    v_mul_f32 v97, v50, v89
    v_fma_f32 v96, -v51, v89, v96
    v_fma_f32 v97, -v51, v88, -v97
    v_mul_f32 v90, v90, v82
    v_mul_f32 v91, v91, v82
    v_mul_f32 v92, v92, v84
    v_mul_f32 v93, v93, v84
    v_mul_f32 v94, v94, v86
    v_mul_f32 v95, v95, v86
    v_mul_f32 v96, v96, v80
    v_mul_f32 v97, v97, v80
    v_cvt_pk_bf16_f32 v130, v90, v91
    v_cvt_pk_bf16_f32 v134, v92, v93
    v_cvt_pk_bf16_f32 v138, v94, v95
    v_cvt_pk_bf16_f32 v142, v96, v97
    s_waitcnt lgkmcnt(0)
    ds_read_b128 v[48:51], v28 offset:64
    v_mul_f32 v73, v53, v20
    v_mul_f32 v75, v53, v22
    v_mul_f32 v77, v53, v24
    v_mul_f32 v79, v53, v26
    v_mul_f32 v72, v52, v20
    v_mul_f32 v74, v52, v22
    v_mul_f32 v76, v52, v24
    v_mul_f32 v78, v52, v26
    v_fract_f32 v77, v77
    s_waitcnt lgkmcnt(0)
    s_barrier
    v_lshrrev_b32 v104, 5, v1
    v_bfe_u32 v105, v1, 2, 2
    v_lshl_add_u32 v104, v104, 3, v105
    v_lshlrev_b32 v104, 8, v104
    v_bfe_u32 v106, v1, 4, 1
    v_lshl_add_u32 v104, v106, 5, v104
    v_and_b32 v106, 3, v1
    v_lshl_add_u32 v104, v106, 3, v104
    v_xor_b32 v105, s101, v105
    v_lshl_add_u32 v104, v105, 6, v104
    ds_read_b64_tr_b16 v[112:113], v104 offset:8192
    ds_read_b64_tr_b16 v[114:115], v104 offset:9216
    ds_read_b64_tr_b16 v[116:117], v104 offset:12288
    ds_read_b64_tr_b16 v[118:119], v104 offset:13312
    s_waitcnt lgkmcnt(0)
    v_lshlrev_b32 v120, 16, v112
    v_and_b32 v121, 0xffff0000, v112
    v_add_f32 v124, v120, v121
    v_lshlrev_b32 v122, 16, v113
    v_and_b32 v123, 0xffff0000, v113
    v_add_f32 v124, v124, v122
    v_add_f32 v124, v124, v123
    v_lshlrev_b32 v120, 16, v114
    v_and_b32 v121, 0xffff0000, v114
    v_add_f32 v124, v124, v120
    v_add_f32 v124, v124, v121
    v_lshlrev_b32 v122, 16, v115
    v_and_b32 v123, 0xffff0000, v115
    v_add_f32 v124, v124, v122
    v_add_f32 v124, v124, v123
    v_lshlrev_b32 v120, 16, v116
    v_and_b32 v121, 0xffff0000, v116
    v_add_f32 v124, v124, v120
    v_add_f32 v124, v124, v121
    v_lshlrev_b32 v122, 16, v117
    v_and_b32 v123, 0xffff0000, v117
    v_add_f32 v124, v124, v122
    v_add_f32 v124, v124, v123
    v_lshlrev_b32 v120, 16, v118
    v_and_b32 v121, 0xffff0000, v118
    v_add_f32 v124, v124, v120
    v_add_f32 v124, v124, v121
    v_lshlrev_b32 v122, 16, v119
    v_and_b32 v123, 0xffff0000, v119
    v_add_f32 v124, v124, v122
    v_add_f32 v124, v124, v123
    v_mov_b32 v125, v124
    s_nop 1
    v_permlane32_swap_b32 v124, v125
    v_add_f32 v124, v124, v125
    s_lshl_b32 s68, s65, 13
    s_lshl_b32 s69, s66, 9
    s_add_u32 s68, s68, s69
    s_lshl_b32 s69, s101, 7
    s_add_u32 s68, s68, s69
    s_add_u32 s68, s68, 11730944
    v_lshlrev_b32 v104, 2, v1
    s_mov_b32 exec_hi, 0
    buffer_store_dword v124, v104, s[52:55], s68 offen sc1
    s_mov_b64 exec, -1
    v_mov_b32 v111, 0
    global_load_dword v110, v111, s[34:35] sc1
    v_fract_f32 v79, v79
    v_cos_f32 v88, v73
    v_cos_f32 v90, v75
    v_cos_f32 v92, v77
    v_cos_f32 v94, v79
    v_sin_f32 v89, v73
    v_sin_f32 v91, v75
    v_sin_f32 v93, v77
    v_sin_f32 v95, v79
    v_exp_f32 v80, v72
    v_exp_f32 v82, v74
    v_exp_f32 v84, v76
    v_exp_f32 v86, v78
    v_mul_f32 v96, v54, v88
    v_mul_f32 v97, v54, v89
    v_fma_f32 v96, -v55, v89, v96
    v_fma_f32 v97, -v55, v88, -v97
    v_mul_f32 v90, v90, v82
    v_mul_f32 v91, v91, v82
    v_mul_f32 v92, v92, v84
    v_mul_f32 v93, v93, v84
    v_mul_f32 v94, v94, v86
    v_mul_f32 v95, v95, v86
    v_mul_f32 v96, v96, v80
    v_mul_f32 v97, v97, v80
    v_cvt_pk_bf16_f32 v131, v90, v91
    v_cvt_pk_bf16_f32 v135, v92, v93
    v_cvt_pk_bf16_f32 v139, v94, v95
    v_cvt_pk_bf16_f32 v143, v96, v97
    s_waitcnt lgkmcnt(0)
    ds_read_b128 v[52:55], v28 offset:80
    v_mul_f32 v73, v49, v20
    v_mul_f32 v75, v49, v22
    s_barrier
    v_mul_f32 v77, v49, v24
    v_mul_f32 v79, v49, v26
    v_mul_f32 v72, v48, v20
    v_mul_f32 v74, v48, v22
    v_mul_f32 v76, v48, v24
    v_mul_f32 v78, v48, v26
    v_fract_f32 v77, v77
    v_fract_f32 v79, v79
    v_cos_f32 v88, v73
    v_cos_f32 v90, v75
    v_cos_f32 v92, v77
    v_cos_f32 v94, v79
    v_sin_f32 v89, v73
    v_sin_f32 v91, v75
    v_sin_f32 v93, v77
    v_sin_f32 v95, v79
    v_exp_f32 v80, v72
    v_exp_f32 v82, v74
    v_exp_f32 v84, v76
    v_exp_f32 v86, v78
    v_mul_f32 v96, v50, v88
    v_mul_f32 v97, v50, v89
    v_fma_f32 v96, -v51, v89, v96
    v_fma_f32 v97, -v51, v88, -v97
    v_mul_f32 v90, v90, v82
    v_mul_f32 v91, v91, v82
    v_mul_f32 v92, v92, v84
    v_mul_f32 v93, v93, v84
    v_mul_f32 v94, v94, v86
    v_mul_f32 v95, v95, v86
    v_mul_f32 v96, v96, v80
    s_barrier
    s_waitcnt vmcnt(0)
    v_readfirstlane_b32 s67, v110
    s_nop 0
    s_cmp_lg_u32 s67, 0
    s_cbranch_scc1 L_hn_5
    s_mov_b32 s100, 0
    v_mov_b32 v111, 0
L_pn_6:
    global_load_dword v110, v111, s[34:35] sc1
    s_waitcnt vmcnt(0)
    v_readfirstlane_b32 s67, v110
    s_add_u32 s100, s100, 1
    s_cmp_lg_u32 s67, 0
    s_cbranch_scc1 L_pnx_7
    s_cmp_lt_u32 s100, 30000
    s_cbranch_scc1 L_pn_6
L_pnx_7:
L_hn_5:
    v_mov_b32 v110, 160768
    v_mov_b32 v111, s67
    ds_write_b32 v110, v111
    v_mul_f32 v97, v97, v80
    s_lshl_b32 s68, s60, 7
    s_lshl_b32 s69, s101, 2
    s_add_u32 s68, s68, s69
    s_add_u32 s68, s68, 11599872
    v_mov_b32 v110, s67
    v_mov_b32 v111, 0
    s_mov_b64 s[82:83], exec
    s_mov_b64 exec, 1
    buffer_store_dword v110, v111, s[52:55], s68 offen sc1
    s_mov_b64 exec, s[82:83]
    v_cvt_pk_bf16_f32 v144, v90, v91
    v_cvt_pk_bf16_f32 v148, v92, v93
    v_cvt_pk_bf16_f32 v152, v94, v95
    v_cvt_pk_bf16_f32 v156, v96, v97
    s_waitcnt lgkmcnt(0)
    ds_read_b128 v[48:51], v28 offset:96
    v_mul_f32 v73, v53, v20
    v_mul_f32 v75, v53, v22
    v_mul_f32 v77, v53, v24
    v_mul_f32 v79, v53, v26
    v_mul_f32 v72, v52, v20
    v_mul_f32 v74, v52, v22
    v_mul_f32 v76, v52, v24
    v_mul_f32 v78, v52, v26
    v_fract_f32 v77, v77
    v_fract_f32 v79, v79
    v_cos_f32 v88, v73
    v_cos_f32 v90, v75
    v_cos_f32 v92, v77
    v_cos_f32 v94, v79
    v_sin_f32 v89, v73
    v_sin_f32 v91, v75
    v_sin_f32 v93, v77
    v_sin_f32 v95, v79
    v_exp_f32 v80, v72
    v_exp_f32 v82, v74
    v_exp_f32 v84, v76
    v_exp_f32 v86, v78
    v_mul_f32 v96, v54, v88
    v_mul_f32 v97, v54, v89
    v_fma_f32 v96, -v55, v89, v96
    v_fma_f32 v97, -v55, v88, -v97
    s_barrier
    v_mul_f32 v90, v90, v82
    v_mul_f32 v91, v91, v82
    v_mul_f32 v92, v92, v84
    v_mul_f32 v93, v93, v84
    v_mul_f32 v94, v94, v86
    v_mul_f32 v95, v95, v86
    v_mul_f32 v96, v96, v80
    v_mul_f32 v97, v97, v80
    v_cvt_pk_bf16_f32 v145, v90, v91
    v_cvt_pk_bf16_f32 v149, v92, v93
    v_cvt_pk_bf16_f32 v153, v94, v95
    v_cvt_pk_bf16_f32 v157, v96, v97
    s_waitcnt lgkmcnt(0)
    ds_read_b128 v[52:55], v28 offset:112
    v_mul_f32 v73, v49, v20
    v_mul_f32 v75, v49, v22
    v_mul_f32 v77, v49, v24
    v_mul_f32 v79, v49, v26
    v_mul_f32 v72, v48, v20
    v_mul_f32 v74, v48, v22
    v_mul_f32 v76, v48, v24
    v_mul_f32 v78, v48, v26
    v_fract_f32 v77, v77
    v_fract_f32 v79, v79
    v_cos_f32 v88, v73
    v_cos_f32 v90, v75
    v_cos_f32 v92, v77
    v_cos_f32 v94, v79
    v_sin_f32 v89, v73
    v_sin_f32 v91, v75
    v_sin_f32 v93, v77
    v_sin_f32 v95, v79
    v_exp_f32 v80, v72
    v_exp_f32 v82, v74
    s_barrier
    v_exp_f32 v84, v76
    v_exp_f32 v86, v78
    v_mul_f32 v96, v50, v88
    v_mul_f32 v97, v50, v89
    v_fma_f32 v96, -v51, v89, v96
    v_fma_f32 v97, -v51, v88, -v97
    v_mul_f32 v90, v90, v82
    v_mul_f32 v91, v91, v82
    v_mul_f32 v92, v92, v84
    v_mul_f32 v93, v93, v84
    v_mul_f32 v94, v94, v86
    v_mul_f32 v95, v95, v86
    v_mul_f32 v96, v96, v80
    v_mul_f32 v97, v97, v80
    v_cvt_pk_bf16_f32 v146, v90, v91
    v_cvt_pk_bf16_f32 v150, v92, v93
    v_cvt_pk_bf16_f32 v154, v94, v95
    v_cvt_pk_bf16_f32 v158, v96, v97
    s_waitcnt lgkmcnt(0)
    ds_read_b128 v[48:51], v28 offset:128
    v_mul_f32 v73, v53, v20
    v_mul_f32 v75, v53, v22
    v_mul_f32 v77, v53, v24
    v_mul_f32 v79, v53, v26
    v_mul_f32 v72, v52, v20
    v_mul_f32 v74, v52, v22
    v_mul_f32 v76, v52, v24
    v_mul_f32 v78, v52, v26
    v_fract_f32 v77, v77
    v_fract_f32 v79, v79
    v_cos_f32 v88, v73
    v_cos_f32 v90, v75
    v_cos_f32 v92, v77
    v_cos_f32 v94, v79
    v_sin_f32 v89, v73
    v_sin_f32 v91, v75
    v_sin_f32 v93, v77
    s_barrier
    v_sin_f32 v95, v79
    v_exp_f32 v80, v72
    v_exp_f32 v82, v74
    v_exp_f32 v84, v76
    v_exp_f32 v86, v78
    v_mul_f32 v96, v54, v88
    v_mul_f32 v97, v54, v89
    v_fma_f32 v96, -v55, v89, v96
    v_fma_f32 v97, -v55, v88, -v97
    v_mul_f32 v90, v90, v82
    v_mul_f32 v91, v91, v82
    v_mul_f32 v92, v92, v84
    v_mul_f32 v93, v93, v84
    v_mul_f32 v94, v94, v86
    v_mul_f32 v95, v95, v86
    v_mul_f32 v96, v96, v80
    v_mul_f32 v97, v97, v80
    v_cvt_pk_bf16_f32 v147, v90, v91
    v_cvt_pk_bf16_f32 v151, v92, v93
    v_cvt_pk_bf16_f32 v155, v94, v95
    v_cvt_pk_bf16_f32 v159, v96, v97
    s_waitcnt lgkmcnt(0)
    ds_read_b128 v[52:55], v28 offset:144
    v_mul_f32 v73, v49, v20
    v_mul_f32 v75, v49, v22
    v_mul_f32 v77, v49, v24
    v_mul_f32 v79, v49, v26
    v_mul_f32 v72, v48, v20
    v_mul_f32 v74, v48, v22
    v_mul_f32 v76, v48, v24
    v_mul_f32 v78, v48, v26
    v_fract_f32 v77, v77
    v_fract_f32 v79, v79
    v_cos_f32 v88, v73
    v_cos_f32 v90, v75
    v_cos_f32 v92, v77
    s_barrier
    v_cos_f32 v94, v79
    v_sin_f32 v89, v73
    v_sin_f32 v91, v75
    v_sin_f32 v93, v77
    v_sin_f32 v95, v79
    v_exp_f32 v80, v72
    v_exp_f32 v82, v74
    v_exp_f32 v84, v76
    v_exp_f32 v86, v78
    v_mul_f32 v96, v50, v88
    v_mul_f32 v97, v50, v89
    v_fma_f32 v96, -v51, v89, v96
    v_fma_f32 v97, -v51, v88, -v97
    v_mul_f32 v90, v90, v82
    v_mul_f32 v91, v91, v82
    v_mul_f32 v92, v92, v84
    v_mul_f32 v93, v93, v84
    v_mul_f32 v94, v94, v86
    v_mul_f32 v95, v95, v86
    v_mul_f32 v96, v96, v80
    v_mul_f32 v97, v97, v80
    v_cvt_pk_bf16_f32 v160, v90, v91
    v_cvt_pk_bf16_f32 v164, v92, v93
    v_cvt_pk_bf16_f32 v168, v94, v95
    v_cvt_pk_bf16_f32 v172, v96, v97
    s_waitcnt lgkmcnt(0)
    ds_read_b128 v[48:51], v28 offset:160
    v_mul_f32 v73, v53, v20
    v_mul_f32 v75, v53, v22
    v_mul_f32 v77, v53, v24
    v_mul_f32 v79, v53, v26
    v_mul_f32 v72, v52, v20
    v_mul_f32 v74, v52, v22
    v_mul_f32 v76, v52, v24
    v_mul_f32 v78, v52, v26
    s_barrier
    v_fract_f32 v77, v77
    v_fract_f32 v79, v79
    v_cos_f32 v88, v73
    v_cos_f32 v90, v75
    v_cos_f32 v92, v77
    v_cos_f32 v94, v79
    v_sin_f32 v89, v73
    v_sin_f32 v91, v75
    v_sin_f32 v93, v77
    v_sin_f32 v95, v79
    v_exp_f32 v80, v72
    v_exp_f32 v82, v74
    v_exp_f32 v84, v76
    v_exp_f32 v86, v78
    v_mul_f32 v96, v54, v88
    v_mul_f32 v97, v54, v89
    v_fma_f32 v96, -v55, v89, v96
    v_fma_f32 v97, -v55, v88, -v97
    v_mul_f32 v90, v90, v82
    v_mul_f32 v91, v91, v82
    v_mul_f32 v92, v92, v84
    v_mul_f32 v93, v93, v84
    v_mul_f32 v94, v94, v86
    v_mul_f32 v95, v95, v86
    v_mul_f32 v96, v96, v80
    v_mul_f32 v97, v97, v80
    v_cvt_pk_bf16_f32 v161, v90, v91
    v_cvt_pk_bf16_f32 v165, v92, v93
    v_cvt_pk_bf16_f32 v169, v94, v95
    v_cvt_pk_bf16_f32 v173, v96, v97
    s_waitcnt lgkmcnt(0)
    ds_read_b128 v[52:55], v28 offset:176
    s_barrier
    s_lshl_b32 s68, s64, 8
    s_add_u32 s68, s68, 11567104
    v_bfe_u32 v112, v1, 2, 1
    v_lshlrev_b32 v112, 7, v112
    v_and_b32 v113, 3, v1
    v_lshl_add_u32 v112, v113, 2, v112
    v_add_u32 v112, s68, v112
    v_lshrrev_b32 v114, 2, v1
    v_and_b32 v115, 3, v114
    v_mul_u32_u24 v115, 7, v115
    s_cmp_ge_u32 s65, 7
    s_cselect_b32 s68, 1, 0
    s_mul_i32 s69, s68, 7
    s_sub_u32 s69, s65, s69
    s_add_u32 s69, s69, 4
    v_add_u32 v115, s69, v115
    v_lshrrev_b32 v114, 2, v114
    v_lshlrev_b32 v114, 1, v114
    v_add_u32 v114, s68, v114
    v_lshl_add_u32 v114, v115, 3, v114
    v_lshlrev_b32 v114, 7, v114
    v_lshl_add_u32 v114, v113, 2, v114
    v_add_u32 v114, 11599872, v114
    s_cmp_eq_u32 s101, 1
    s_cselect_b64 vcc, -1, 0
    v_cndmask_b32 v112, v112, v114, vcc
    buffer_load_dword v113, v112, s[52:55], 0 offen sc1
    v_mul_f32 v73, v49, v20
    v_mul_f32 v75, v49, v22
    v_mul_f32 v77, v49, v24
    v_mul_f32 v79, v49, v26
    v_mul_f32 v72, v48, v20
    v_mul_f32 v74, v48, v22
    v_mul_f32 v76, v48, v24
    v_mul_f32 v78, v48, v26
    v_fract_f32 v77, v77
    v_fract_f32 v79, v79
    v_cos_f32 v88, v73
    v_cos_f32 v90, v75
    v_cos_f32 v92, v77
    v_cos_f32 v94, v79
    v_sin_f32 v89, v73
    v_sin_f32 v91, v75
    v_sin_f32 v93, v77
    v_sin_f32 v95, v79
    v_exp_f32 v80, v72
    v_exp_f32 v82, v74
    v_exp_f32 v84, v76
    v_exp_f32 v86, v78
    v_mul_f32 v96, v50, v88
    v_mul_f32 v97, v50, v89
    v_fma_f32 v96, -v51, v89, v96
    v_fma_f32 v97, -v51, v88, -v97
    v_mul_f32 v90, v90, v82
    v_mul_f32 v91, v91, v82
    v_mul_f32 v92, v92, v84
    v_mul_f32 v93, v93, v84
    v_mul_f32 v94, v94, v86
    v_mul_f32 v95, v95, v86
    s_barrier
    v_mul_f32 v96, v96, v80
    v_mul_f32 v97, v97, v80
    v_cvt_pk_bf16_f32 v162, v90, v91
    v_cvt_pk_bf16_f32 v166, v92, v93
    v_cvt_pk_bf16_f32 v170, v94, v95
    v_cvt_pk_bf16_f32 v174, v96, v97
    s_waitcnt lgkmcnt(0)
    ds_read_b128 v[48:51], v28 offset:192
    v_mul_f32 v73, v53, v20
    v_mul_f32 v75, v53, v22
    v_mul_f32 v77, v53, v24
    v_mul_f32 v79, v53, v26
    v_mul_f32 v72, v52, v20
    v_mul_f32 v74, v52, v22
    v_mul_f32 v76, v52, v24
    v_mul_f32 v78, v52, v26
    v_fract_f32 v77, v77
    v_fract_f32 v79, v79
    v_cos_f32 v88, v73
    v_cos_f32 v90, v75
    v_cos_f32 v92, v77
    v_cos_f32 v94, v79
    v_sin_f32 v89, v73
    v_sin_f32 v91, v75
    v_sin_f32 v93, v77
    v_sin_f32 v95, v79
    v_exp_f32 v80, v72
    v_exp_f32 v82, v74
    v_exp_f32 v84, v76
    v_exp_f32 v86, v78
    v_mul_f32 v96, v54, v88
    v_mul_f32 v97, v54, v89
    s_barrier
    v_fma_f32 v96, -v55, v89, v96
    v_fma_f32 v97, -v55, v88, -v97
    v_mul_f32 v90, v90, v82
    v_mul_f32 v91, v91, v82
    v_mul_f32 v92, v92, v84
    v_mul_f32 v93, v93, v84
    v_mul_f32 v94, v94, v86
    v_mul_f32 v95, v95, v86
    v_mul_f32 v96, v96, v80
    v_mul_f32 v97, v97, v80
    v_cvt_pk_bf16_f32 v163, v90, v91
    v_cvt_pk_bf16_f32 v167, v92, v93
    v_cvt_pk_bf16_f32 v171, v94, v95
    v_cvt_pk_bf16_f32 v175, v96, v97
    s_waitcnt lgkmcnt(0)
    ds_read_b128 v[52:55], v28 offset:208
    v_mul_f32 v73, v49, v20
    v_mul_f32 v75, v49, v22
    v_mul_f32 v77, v49, v24
    v_mul_f32 v79, v49, v26
    v_mul_f32 v72, v48, v20
    v_mul_f32 v74, v48, v22
    v_mul_f32 v76, v48, v24
    v_mul_f32 v78, v48, v26
    v_fract_f32 v77, v77
    v_fract_f32 v79, v79
    v_cos_f32 v88, v73
    v_cos_f32 v90, v75
    v_cos_f32 v92, v77
    v_cos_f32 v94, v79
    v_sin_f32 v89, v73
    v_sin_f32 v91, v75
    v_sin_f32 v93, v77
    v_sin_f32 v95, v79
    v_exp_f32 v80, v72
    v_exp_f32 v82, v74
    s_barrier
    s_cmp_ge_u32 s101, 2
    s_cbranch_scc1 L_hf_8x
    s_waitcnt vmcnt(0)
    v_cmp_ne_u32 vcc, s67, v113
    s_nop 4
    s_cbranch_vccz L_hf_8
    s_mov_b32 s100, 0
    s_mov_b64 s[82:83], exec
L_pf_10:
    buffer_load_dword v113, v112, s[52:55], 0 offen sc1
    s_waitcnt vmcnt(0)
    v_cmp_ne_u32 vcc, s67, v113
    s_add_u32 s100, s100, 1
    s_nop 3
    s_cbranch_vccz L_pfx_11
    s_cmp_lt_u32 s100, 30000
    s_cbranch_scc1 L_pf_10
L_pfx_11:
    s_mov_b64 exec, s[82:83]
L_hf_8:
    s_lshl_b32 s68, s64, 10
    s_add_u32 s68, s68, 11534336
    s_lshl_b32 s69, s65, 13
    s_add_u32 s69, s69, 11730944
    v_lshlrev_b32 v112, 4, v1
    s_cmp_eq_u32 s101, 1
    s_cbranch_scc1 L_hc_9
    buffer_load_dwordx4 v[196:199], v112, s[52:55], s68 offen sc1
    s_nop 0
    s_nop 0
    s_nop 0
    s_nop 0
    s_nop 0
    s_nop 0
    s_nop 0
    s_branch L_hf_8d
L_hc_9:
    buffer_load_dwordx4 v[196:199], v112, s[52:55], s69 offen offset:0 sc1
    buffer_load_dwordx4 v[200:203], v112, s[52:55], s69 offen offset:1024 sc1
    buffer_load_dwordx4 v[204:207], v112, s[52:55], s69 offen offset:2048 sc1
    buffer_load_dwordx4 v[208:211], v112, s[52:55], s69 offen offset:3072 sc1
    s_add_u32 s69, s69, 4096
    buffer_load_dwordx4 v[212:215], v112, s[52:55], s69 offen offset:0 sc1
    buffer_load_dwordx4 v[216:219], v112, s[52:55], s69 offen offset:1024 sc1
    buffer_load_dwordx4 v[220:223], v112, s[52:55], s69 offen offset:2048 sc1
    buffer_load_dwordx4 v[224:227], v112, s[52:55], s69 offen offset:3072 sc1
L_hf_8d:
L_hf_8x:
    v_exp_f32 v84, v76
    v_exp_f32 v86, v78
    v_mul_f32 v96, v50, v88
    v_mul_f32 v97, v50, v89
    v_fma_f32 v96, -v51, v89, v96
    v_fma_f32 v97, -v51, v88, -v97
    v_mul_f32 v90, v90, v82
    v_mul_f32 v91, v91, v82
    v_mul_f32 v92, v92, v84
    v_mul_f32 v93, v93, v84
    v_mul_f32 v94, v94, v86
    v_mul_f32 v95, v95, v86
    v_mul_f32 v96, v96, v80
    v_mul_f32 v97, v97, v80
    v_cvt_pk_bf16_f32 v176, v90, v91
    v_cvt_pk_bf16_f32 v180, v92, v93
    v_cvt_pk_bf16_f32 v184, v94, v95
    v_cvt_pk_bf16_f32 v188, v96, v97
    s_waitcnt lgkmcnt(0)
    ds_read_b128 v[48:51], v28 offset:224
    v_mul_f32 v73, v53, v20
    v_mul_f32 v75, v53, v22
    v_mul_f32 v77, v53, v24
    v_mul_f32 v79, v53, v26
    v_mul_f32 v72, v52, v20
    v_mul_f32 v74, v52, v22
    v_mul_f32 v76, v52, v24
    v_mul_f32 v78, v52, v26
    v_fract_f32 v77, v77
    v_fract_f32 v79, v79
    v_cos_f32 v88, v73
    v_cos_f32 v90, v75
    v_cos_f32 v92, v77
    v_cos_f32 v94, v79
    v_sin_f32 v89, v73
    v_sin_f32 v91, v75
    s_barrier
    v_sin_f32 v93, v77
    v_sin_f32 v95, v79
    v_exp_f32 v80, v72
    v_exp_f32 v82, v74
    v_exp_f32 v84, v76
    v_exp_f32 v86, v78
    v_mul_f32 v96, v54, v88
    v_mul_f32 v97, v54, v89
    v_fma_f32 v96, -v55, v89, v96
    v_fma_f32 v97, -v55, v88, -v97
    v_mul_f32 v90, v90, v82
    v_mul_f32 v91, v91, v82
    v_mul_f32 v92, v92, v84
    v_mul_f32 v93, v93, v84
    v_mul_f32 v94, v94, v86
    v_mul_f32 v95, v95, v86
    v_mul_f32 v96, v96, v80
    v_mul_f32 v97, v97, v80
    v_cvt_pk_bf16_f32 v177, v90, v91
    v_cvt_pk_bf16_f32 v181, v92, v93
    v_cvt_pk_bf16_f32 v185, v94, v95
    v_cvt_pk_bf16_f32 v189, v96, v97
    s_waitcnt lgkmcnt(0)
    ds_read_b128 v[52:55], v28 offset:240
    v_mul_f32 v73, v49, v20
    v_mul_f32 v75, v49, v22
    v_mul_f32 v77, v49, v24
    v_mul_f32 v79, v49, v26
    v_mul_f32 v72, v48, v20
    v_mul_f32 v74, v48, v22
    v_mul_f32 v76, v48, v24
    v_mul_f32 v78, v48, v26
    v_fract_f32 v77, v77
    v_fract_f32 v79, v79
    v_cos_f32 v88, v73
    v_cos_f32 v90, v75
    s_barrier
    s_cmp_ge_u32 s101, 2
    s_cbranch_scc1 L_hw_12
    s_waitcnt vmcnt(0)
    s_cmp_eq_u32 s101, 0
    s_cbranch_scc1 L_hz_13
    v_add_f32 v196, v196, v200
    v_add_f32 v197, v197, v201
    v_add_f32 v198, v198, v202
    v_add_f32 v199, v199, v203
    v_add_f32 v196, v196, v204
    v_add_f32 v197, v197, v205
    v_add_f32 v198, v198, v206
    v_add_f32 v199, v199, v207
    v_add_f32 v196, v196, v208
    v_add_f32 v197, v197, v209
    v_add_f32 v198, v198, v210
    v_add_f32 v199, v199, v211
    v_add_f32 v196, v196, v212
    v_add_f32 v197, v197, v213
    v_add_f32 v198, v198, v214
    v_add_f32 v199, v199, v215
    v_add_f32 v196, v196, v216
    v_add_f32 v197, v197, v217
    v_add_f32 v198, v198, v218
    v_add_f32 v199, v199, v219
    v_add_f32 v196, v196, v220
    v_add_f32 v197, v197, v221
    v_add_f32 v198, v198, v222
    v_add_f32 v199, v199, v223
    v_add_f32 v196, v196, v224
    v_add_f32 v197, v197, v225
    v_add_f32 v198, v198, v226
    v_add_f32 v199, v199, v227
    v_mov_b32 v200, v196
    v_mov_b32 v201, v197
    v_mov_b32 v202, v198
    v_mov_b32 v203, v199
    v_permlane32_swap_b32 v196, v200
    v_permlane32_swap_b32 v197, v201
    v_permlane32_swap_b32 v198, v202
    v_permlane32_swap_b32 v199, v203
    v_add_f32 v196, v196, v200
    v_add_f32 v197, v197, v201
    v_add_f32 v198, v198, v202
    v_add_f32 v199, v199, v203
L_hz_13:
    s_lshl_b32 s68, s101, 10
    s_add_u32 s68, s68, 0
    v_add_u32 v112, s68, v112
    ds_write_b128 v112, v[196:199]
L_hw_12:
    s_waitcnt lgkmcnt(0)
    v_cos_f32 v92, v77
    v_cos_f32 v94, v79
    v_sin_f32 v89, v73
    v_sin_f32 v91, v75
    v_sin_f32 v93, v77
    v_sin_f32 v95, v79
    v_exp_f32 v80, v72
    v_exp_f32 v82, v74
    v_exp_f32 v84, v76
    v_exp_f32 v86, v78
    v_mul_f32 v96, v50, v88
    v_mul_f32 v97, v50, v89
    v_fma_f32 v96, -v51, v89, v96
    v_fma_f32 v97, -v51, v88, -v97
    v_mul_f32 v90, v90, v82
    v_mul_f32 v91, v91, v82
    v_mul_f32 v92, v92, v84
    v_mul_f32 v93, v93, v84
    v_mul_f32 v94, v94, v86
    v_mul_f32 v95, v95, v86
    v_mul_f32 v96, v96, v80
    v_mul_f32 v97, v97, v80
    v_cvt_pk_bf16_f32 v178, v90, v91
    v_cvt_pk_bf16_f32 v182, v92, v93
    v_cvt_pk_bf16_f32 v186, v94, v95
    v_cvt_pk_bf16_f32 v190, v96, v97
    s_waitcnt lgkmcnt(0)
    v_mul_f32 v73, v53, v20
    v_mul_f32 v75, v53, v22
    v_mul_f32 v77, v53, v24
    v_mul_f32 v79, v53, v26
    v_mul_f32 v72, v52, v20
    v_mul_f32 v74, v52, v22
    v_mul_f32 v76, v52, v24
    s_barrier
    v_mul_f32 v78, v52, v26
    v_fract_f32 v77, v77
    v_fract_f32 v79, v79
    v_cos_f32 v88, v73
    v_cos_f32 v90, v75
    v_cos_f32 v92, v77
    v_cos_f32 v94, v79
    v_sin_f32 v89, v73
    v_sin_f32 v91, v75
    v_sin_f32 v93, v77
    v_sin_f32 v95, v79
    v_exp_f32 v80, v72
    v_exp_f32 v82, v74
    v_exp_f32 v84, v76
    v_exp_f32 v86, v78
    v_mul_f32 v96, v54, v88
    v_mul_f32 v97, v54, v89
    v_fma_f32 v96, -v55, v89, v96
    v_fma_f32 v97, -v55, v88, -v97
    v_mul_f32 v90, v90, v82
    v_mul_f32 v91, v91, v82
    v_mul_f32 v92, v92, v84
    v_mul_f32 v93, v93, v84
    v_mul_f32 v94, v94, v86
    v_mul_f32 v95, v95, v86
    v_mul_f32 v96, v96, v80
    v_mul_f32 v97, v97, v80
    v_cvt_pk_bf16_f32 v179, v90, v91
    v_cvt_pk_bf16_f32 v183, v92, v93
    v_cvt_pk_bf16_f32 v187, v94, v95
    v_cvt_pk_bf16_f32 v191, v96, v97
    s_barrier
    v_mfma_f32_16x16x32_bf16 v[32:35], v[128:131], v[140:143], 0
    v_mfma_f32_16x16x32_bf16 v[36:39], v[132:135], v[140:143], 0
    v_mfma_f32_16x16x32_bf16 v[40:43], v[136:139], v[140:143], 0
    v_mfma_f32_16x16x32_bf16 v[32:35], v[144:147], v[156:159], v[32:35]
    v_mfma_f32_16x16x32_bf16 v[36:39], v[148:151], v[156:159], v[36:39]
    v_mfma_f32_16x16x32_bf16 v[40:43], v[152:155], v[156:159], v[40:43]
    v_mfma_f32_16x16x32_bf16 v[32:35], v[160:163], v[172:175], v[32:35]
    v_mfma_f32_16x16x32_bf16 v[36:39], v[164:167], v[172:175], v[36:39]
    v_mfma_f32_16x16x32_bf16 v[40:43], v[168:171], v[172:175], v[40:43]
    v_mfma_f32_16x16x32_bf16 v[32:35], v[176:179], v[188:191], v[32:35]
    v_mfma_f32_16x16x32_bf16 v[36:39], v[180:183], v[188:191], v[36:39]
    v_mfma_f32_16x16x32_bf16 v[40:43], v[184:187], v[188:191], v[40:43]
    s_setprio 3
    s_lshr_b32 s68, s101, 1
    s_mul_i32 s68, s68, 3072
    s_add_u32 s68, s68, 154624
    v_and_b32 v10, 15, v1
    v_lshrrev_b32 v11, 4, v1
    v_lshlrev_b32 v12, 3, v10
    v_and_b32 v13, 1, v11
    v_lshl_add_u32 v12, v13, 2, v12
    v_lshrrev_b32 v13, 1, v11
    v_lshl_add_u32 v12, v13, 7, v12
    v_lshlrev_b32 v12, 2, v12
    v_add_u32 v12, s68, v12
    v_lshlrev_b32 v13, 2, v10
    v_lshl_add_u32 v13, v11, 6, v13
    v_add_u32 v13, 256, v13
    v_lshlrev_b32 v14, 1, v10
    v_lshl_add_u32 v14, v11, 6, v14
    v_add_u32 v14, 256, v14
    v_cmp_gt_u32 vcc, 2, v11
    s_nop 1
    v_cndmask_b32 v13, v14, v13, vcc
    v_mov_b32 v15, 32
    v_cndmask_b32 v15, v15, 2, vcc
    v_add_u32 v14, v13, v15
    v_lshlrev_b32 v13, 2, v13
    v_lshlrev_b32 v14, 2, v14
    v_add_u32 v13, s68, v13
    v_add_u32 v14, s68, v14
    v_lshl_add_u32 v15, v11, 6, v10
    v_add_u32 v15, 512, v15
    v_lshlrev_b32 v15, 2, v15
    v_add_u32 v15, s68, v15
    s_bitcmp0_b32 s101, 0
    s_cbranch_scc1 L_tw_14
    ds_write_b128 v12, v[32:35]
    ds_write_b64 v13, v[36:37]
    ds_write_b64 v14, v[38:39]
    ds_write_b32 v15, v40 offset:0
    ds_write_b32 v15, v41 offset:64
    ds_write_b32 v15, v42 offset:128
    ds_write_b32 v15, v43 offset:192
    s_waitcnt lgkmcnt(0)
L_tw_14:
    s_bitcmp0_b32 s101, 0
    s_cbranch_scc1 L_k0_15
    s_lshl_b32 s74, s101, 2
    s_add_u32 s74, s74, 160832
    v_mov_b32 v122, s74
    v_mov_b32 v123, 1
    ds_write_b32 v122, v123
    s_branch L_k1_16
L_k0_15:
    s_cmp_eq_u32 s101, 0
    s_cbranch_scc0 L_c2_17
    v_mov_b32 v120, 160836
    s_mov_b32 s100, 0
L_ls_19:
    ds_read_b32 v116, v120
    s_waitcnt lgkmcnt(0)
    v_readfirstlane_b32 s74, v116
    s_nop 0
    s_cmp_ge_u32 s74, 1
    s_cbranch_scc1 L_lsx_20
    s_add_u32 s100, s100, 1
    s_cmp_lt_u32 s100, 0x400000
    s_cbranch_scc1 L_ls_19
L_lsx_20:
    s_branch L_c3_18
L_c2_17:
    v_mov_b32 v120, 160844
    s_mov_b32 s100, 0
L_ls_21:
    ds_read_b32 v116, v120
    s_waitcnt lgkmcnt(0)
    v_readfirstlane_b32 s74, v116
    s_nop 0
    s_cmp_ge_u32 s74, 1
    s_cbranch_scc1 L_lsx_22
    s_add_u32 s100, s100, 1
    s_cmp_lt_u32 s100, 0x400000
    s_cbranch_scc1 L_ls_21
L_lsx_22:
L_c3_18:
    s_bitcmp1_b32 s101, 0
    s_cbranch_scc1 L_ta_23
    ds_read_b128 v[44:47], v12
    ds_read_b64 v[48:49], v13
    ds_read_b64 v[50:51], v14
    ds_read_b32 v52, v15 offset:0
    ds_read_b32 v53, v15 offset:64
    ds_read_b32 v54, v15 offset:128
    ds_read_b32 v55, v15 offset:192
    s_waitcnt lgkmcnt(0)
    v_add_f32 v32, v32, v44
    v_add_f32 v33, v33, v45
    v_add_f32 v34, v34, v46
    v_add_f32 v35, v35, v47
    v_add_f32 v36, v36, v48
    v_add_f32 v37, v37, v49
    v_add_f32 v38, v38, v50
    v_add_f32 v39, v39, v51
    v_add_f32 v40, v40, v52
    v_add_f32 v41, v41, v53
    v_add_f32 v42, v42, v54
    v_add_f32 v43, v43, v55
    ds_write_b128 v12, v[32:35]
    ds_write_b64 v13, v[36:37]
    ds_write_b64 v14, v[38:39]
    ds_write_b32 v15, v40 offset:0
    ds_write_b32 v15, v41 offset:64
    ds_write_b32 v15, v42 offset:128
    ds_write_b32 v15, v43 offset:192
    s_waitcnt lgkmcnt(0)
L_ta_23:
    s_lshl_b32 s74, s101, 2
    s_add_u32 s74, s74, 160832
    v_mov_b32 v122, s74
    v_mov_b32 v123, 1
    ds_write_b32 v122, v123
L_k1_16:
    s_lshr_b32 s68, s60, 6
    s_lshl_b32 s68, s68, 2
    s_add_u32 s68, s68, 11632640
    v_and_b32 v100, 31, v1
    v_lshlrev_b32 v100, 7, v100
    v_add_u32 v100, s68, v100
    buffer_load_dword v101, v100, s[52:55], 0 offen sc1
    v_mov_b32 v120, 160832
    s_mov_b32 s100, 0
L_ls_24:
    ds_read_b128 v[116:119], v120
    s_waitcnt lgkmcnt(0)
    v_min_u32 v116, v116, v117
    v_min3_u32 v116, v116, v118, v119
    s_nop 0
    v_readfirstlane_b32 s74, v116
    s_nop 0
    s_cmp_ge_u32 s74, 1
    s_cbranch_scc1 L_lsx_25
    s_add_u32 s100, s100, 1
    s_cmp_lt_u32 s100, 0x400000
    s_cbranch_scc1 L_ls_24
L_lsx_25:
    s_lshr_b32 s68, s101, 1
    s_and_b32 s69, s101, 1
    s_lshl_b32 s69, s69, 6
    v_add_u32 v10, s69, v1
    s_mul_i32 s70, s68, 3072
    s_add_u32 s70, s70, 156672
    v_lshlrev_b32 v11, 2, v10
    v_add_u32 v11, s70, v11
    ds_read_b32 v20, v11 offset:0
    ds_read_b32 v21, v11 offset:4
    v_add_u32 v12, 128, v10
    s_mul_i32 s70, s68, 11520
    v_mov_b32 v13, s70
    v_lshrrev_b32 v14, 2, v12
    v_mul_u32_u24 v14, 160, v14
    v_and_b32 v15, 3, v12
    v_lshl_add_u32 v14, v15, 4, v14
    v_add_u32 v14, 132864, v14
    v_add_u32 v14, v14, v13
    v_add_u32 v15, 72, v14
    v_and_b32 v16, 1, v10
    v_cmp_eq_u32 vcc, 0, v16
    s_waitcnt lgkmcnt(0)
    s_nop 0
    v_cndmask_b32 v22, v21, v20, vcc
    v_cvt_pk_bf16_f32 v44, v20, v20
    v_mov_b32 v45, v44
    v_cvt_pk_bf16_f32 v46, v22, v21
    v_cvt_pk_bf16_f32 v47, v21, v21
    v_mov_b32 v40, v44
    v_mov_b32 v41, v44
    v_cvt_pk_bf16_f32 v42, v20, v22
    v_mov_b32 v43, v47
    ds_write_b64 v14, v[40:41]
    ds_write_b64 v14, v[42:43] offset:8
    ds_write_b64 v15, v[44:45]
    ds_write_b64 v15, v[46:47] offset:8
    s_waitcnt vmcnt(0)
    v_cmp_ne_u32 vcc, s67, v101
    s_nop 4
    s_cbranch_vccz L_xf_26
    s_mov_b32 s100, 0
    s_mov_b64 s[82:83], exec
L_pf_27:
    buffer_load_dword v101, v100, s[52:55], 0 offen sc1
    s_waitcnt vmcnt(0)
    v_cmp_ne_u32 vcc, s67, v101
    s_add_u32 s100, s100, 1
    s_nop 3
    s_cbranch_vccz L_pfx_28
    s_cmp_lt_u32 s100, 30000
    s_cbranch_scc1 L_pf_27
L_pfx_28:
    s_mov_b64 exec, s[82:83]
L_xf_26:
    s_mul_i32 s70, s101, 4224
    s_add_u32 s70, s70, 114688
    s_lshr_b32 s72, s101, 1
    s_lshl_b32 s73, s60, 1
    s_add_u32 s72, s72, s73
    s_lshl_b32 s72, s72, 12
    s_and_b32 s73, s101, 1
    s_xor_b32 s73, s73, 1
    s_lshl_b32 s73, s73, 2
    s_add_u32 s72, s72, s73
    s_add_u32 s72, s72, 7340032
    v_lshlrev_b32 v10, 4, v1
    s_mov_b32 m0, s70
    s_nop 0
    buffer_load_dwordx4 v10, s[52:55], s72 offen offset:0 sc1 lds
    buffer_load_dwordx4 v10, s[52:55], s72 offen offset:1024 sc1 lds
    buffer_load_dwordx4 v10, s[52:55], s72 offen offset:2048 sc1 lds
    buffer_load_dwordx4 v10, s[52:55], s72 offen offset:3072 sc1 lds
    s_cmp_eq_u32 s101, 1
    s_cbranch_scc1 L_r1_29
    s_cmp_ge_u32 s101, 2
    s_cbranch_scc1 L_r2_30
    v_lshrrev_b32 v16, 5, v1
    v_and_b32 v12, 31, v1
    v_mul_u32_u24 v11, 3072, v16
    v_lshl_add_u32 v11, v12, 5, v11
    v_add_u32 v11, 154624, v11
    ds_read_b128 v[20:23], v11 offset:0
    ds_read_b128 v[24:27], v11 offset:16
    v_add_u32 v17, -4, v11
    ds_read_b32 v28, v17 offset:0
    v_mul_u32_u24 v13, 11520, v16
    v_lshrrev_b32 v14, 2, v12
    v_mul_u32_u24 v14, 160, v14
    v_and_b32 v15, 3, v12
    v_lshl_add_u32 v14, v15, 4, v14
    v_add_u32 v14, 132864, v14
    v_add_u32 v14, v14, v13
    v_add_u32 v15, 72, v14
    v_cmp_eq_u32 vcc, 0, v12
    s_waitcnt lgkmcnt(0)
    s_nop 0
    v_cndmask_b32 v28, v28, 0, vcc
    v_cvt_pk_bf16_f32 v44, v20, v21
    v_cvt_pk_bf16_f32 v45, v22, v23
    v_cvt_pk_bf16_f32 v46, v24, v25
    v_cvt_pk_bf16_f32 v47, v26, v27
    v_cvt_pk_bf16_f32 v40, v28, v20
    v_cvt_pk_bf16_f32 v41, v21, v22
    v_cvt_pk_bf16_f32 v42, v23, v24
    v_cvt_pk_bf16_f32 v43, v25, v26
    ds_write_b64 v14, v[40:41]
    ds_write_b64 v14, v[42:43] offset:8
    ds_write_b64 v15, v[44:45]
    ds_write_b64 v15, v[46:47] offset:8
    s_branch L_rx_31
L_r1_29:
    v_lshrrev_b32 v16, 5, v1
    v_and_b32 v12, 31, v1
    v_mul_u32_u24 v11, 3072, v16
    v_lshl_add_u32 v11, v12, 4, v11
    v_add_u32 v11, 155648, v11
    ds_read_b128 v[20:23], v11 offset:0
    ds_read_b32 v24, v11 offset:16
    v_add_u32 v17, -4, v11
    ds_read_b32 v28, v17 offset:0
    v_cmp_eq_u32 vcc, 0, v12
    v_add_u32 v12, 32, v12
    v_mul_u32_u24 v13, 11520, v16
    v_lshrrev_b32 v14, 2, v12
    v_mul_u32_u24 v14, 160, v14
    v_and_b32 v15, 3, v12
    v_lshl_add_u32 v14, v15, 4, v14
    v_add_u32 v14, 132864, v14
    v_add_u32 v14, v14, v13
    v_add_u32 v15, 72, v14
    s_waitcnt lgkmcnt(0)
    v_cndmask_b32 v28, v20, v28, vcc
    v_cvt_pk_bf16_f32 v44, v20, v20
    v_cvt_pk_bf16_f32 v45, v21, v22
    v_cvt_pk_bf16_f32 v46, v22, v22
    v_cvt_pk_bf16_f32 v47, v23, v24
    v_cvt_pk_bf16_f32 v40, v28, v20
    v_cvt_pk_bf16_f32 v41, v20, v21
    v_mov_b32 v42, v46
    v_cvt_pk_bf16_f32 v43, v22, v23
    ds_write_b64 v14, v[40:41]
    ds_write_b64 v14, v[42:43] offset:8
    ds_write_b64 v15, v[44:45]
    ds_write_b64 v15, v[46:47] offset:8
    s_branch L_rx_31
L_r2_30:
    s_sub_u32 s68, s101, 2
    s_mul_i32 s70, s68, 3072
    s_add_u32 s70, s70, 156160
    v_lshlrev_b32 v11, 3, v1
    v_add_u32 v11, s70, v11
    ds_read_b64 v[20:21], v11 offset:0
    ds_read_b32 v22, v11 offset:8
    v_add_u32 v12, 64, v1
    s_mul_i32 s70, s68, 11520
    v_mov_b32 v13, s70
    v_lshrrev_b32 v14, 2, v12
    v_mul_u32_u24 v14, 160, v14
    v_and_b32 v15, 3, v12
    v_lshl_add_u32 v14, v15, 4, v14
    v_add_u32 v14, 132864, v14
    v_add_u32 v14, v14, v13
    v_add_u32 v15, 72, v14
    s_waitcnt lgkmcnt(0)
    v_cvt_pk_bf16_f32 v44, v20, v20
    v_cvt_pk_bf16_f32 v45, v20, v21
    v_cvt_pk_bf16_f32 v46, v21, v21
    v_cvt_pk_bf16_f32 v47, v22, v22
    v_mov_b32 v40, v44
    v_mov_b32 v41, v44
    v_mov_b32 v42, v46
    v_cvt_pk_bf16_f32 v43, v21, v22
    ds_write_b64 v14, v[40:41]
    ds_write_b64 v14, v[42:43] offset:8
    ds_write_b64 v15, v[44:45]
    ds_write_b64 v15, v[46:47] offset:8
L_rx_31:
    s_waitcnt lgkmcnt(0)
    s_setprio 0
    s_waitcnt vmcnt(0)
    s_mul_i32 s70, s101, 4224
    s_add_u32 s70, s70, 114688
    s_and_b32 s73, s101, 1
    s_lshl_b32 s73, s73, 2
    s_add_u32 s70, s70, s73
    s_add_u32 s70, s70, 4092
    v_lshlrev_b32 v10, 2, v1
    v_add_u32 v10, s70, v10
    v_mov_b32 v11, 0
    s_mov_b64 exec, 0xffffffff
    ds_write_b32 v10, v11
    s_mov_b64 exec, -1
    s_lshl_b32 s4, s85, 7
    s_mul_i32 s5, s101, 4
    s_branch L_join1
L_M:
    s_cmp_lt_u32 s60, 32
    s_cbranch_scc1 L_LN
    v_and_b32 v10, 31, v1
    v_lshrrev_b32 v11, 5, v1
    v_lshrrev_b32 v12, 2, v10
    v_and_b32 v12, 3, v12
    v_xor_b32 v12, v12, v11
    v_lshlrev_b32 v12, 4, v12
    s_lshl_b32 s68, s86, 6
    v_add_u32 v10, s68, v10
    v_lshl_add_u32 v6, v10, 6, v12
    v_xor_b32 v7, 32, v6
    v_bfe_u32 v10, v1, 2, 2
    v_lshl_add_u32 v12, v11, 3, v10
    v_lshlrev_b32 v12, 8, v12
    v_bfe_u32 v13, v1, 4, 1
    v_lshl_add_u32 v12, v13, 5, v12
    v_and_b32 v13, 3, v1
    v_lshl_add_u32 v12, v13, 3, v12
    v_add_u32 v12, 8192, v12
    s_lshl_b32 s68, s87, 1
    v_xor_b32 v13, s68, v10
    v_lshl_add_u32 v8, v13, 6, v12
    v_xor_b32 v13, 1, v13
    v_lshl_add_u32 v9, v13, 6, v12
    s_lshl_b32 s80, s76, 6
    s_mul_i32 s81, s76, 114688
    s_add_u32 s80, s80, s77
    s_add_u32 m0, s79, 49152
    s_add_u32 s81, s81, s78
    buffer_load_dwordx4 v2, s[40:43], s80 offen lds
    s_add_u32 m0, m0, 1024
    s_add_u32 s76, s76, 1
    buffer_load_dwordx4 v3, s[40:43], s80 offen lds
    s_add_u32 m0, m0, 7168
    s_and_b32 s76, s76, 15
    buffer_load_dwordx4 v4, s[44:47], s81 offen lds
    s_add_u32 m0, m0, 1024
    s_nop 0
    buffer_load_dwordx4 v5, s[44:47], s81 offen lds
    s_sub_u32 s68, s60, 32
    s_lshl_b32 s68, s68, 2
    s_add_u32 s68, s68, s61
    s_mul_i32 s68, s68, 2048
    v_lshlrev_b32 v232, 7, v1
    s_mov_b64 exec, 0xffff
    buffer_load_dword v233, v232, s[48:51], s68 offen
    s_mov_b64 exec, -1
    s_waitcnt vmcnt(13)
    s_barrier
    ds_read_b64_tr_b16 v[20:21], v8 offset:0
    ds_read_b64_tr_b16 v[22:23], v8 offset:1024
    ds_read_b128 v[12:15], v6 offset:0
    ds_read_b64_tr_b16 v[24:25], v9 offset:0
    ds_read_b64_tr_b16 v[26:27], v9 offset:1024
    ds_read_b128 v[16:19], v6 offset:2048
    s_waitcnt lgkmcnt(0)
    v_mfma_f32_32x32x16_bf16 v[44:59], v[20:23], v[12:15], 0
    ds_read_b64_tr_b16 v[36:37], v8 offset:4096
    ds_read_b64_tr_b16 v[38:39], v8 offset:5120
    v_mfma_f32_32x32x16_bf16 v[60:75], v[20:23], v[16:19], 0
    ds_read_b128 v[28:31], v7 offset:0
    ds_read_b64_tr_b16 v[40:41], v9 offset:4096
    v_mfma_f32_32x32x16_bf16 v[76:91], v[24:27], v[12:15], 0
    ds_read_b64_tr_b16 v[42:43], v9 offset:5120
    ds_read_b128 v[32:35], v7 offset:2048
    v_mfma_f32_32x32x16_bf16 v[92:107], v[24:27], v[16:19], 0
    s_waitcnt lgkmcnt(0)
    v_mfma_f32_32x32x16_bf16 v[44:59], v[36:39], v[28:31], v[44:59]
    s_waitcnt vmcnt(9)
    s_barrier
    ds_read_b64_tr_b16 v[20:21], v8 offset:16384
    ds_read_b64_tr_b16 v[22:23], v8 offset:17408
    ds_read_b128 v[12:15], v6 offset:16384
    s_lshl_b32 s80, s76, 6
    s_mul_i32 s81, s76, 114688
    s_add_u32 s80, s80, s77
    s_add_u32 m0, s79, 0
    s_add_u32 s81, s81, s78
    buffer_load_dwordx4 v2, s[40:43], s80 offen lds
    v_mfma_f32_32x32x16_bf16 v[60:75], v[36:39], v[32:35], v[60:75]
    ds_read_b64_tr_b16 v[24:25], v9 offset:16384
    ds_read_b64_tr_b16 v[26:27], v9 offset:17408
    ds_read_b128 v[16:19], v6 offset:18432
    v_mfma_f32_32x32x16_bf16 v[76:91], v[40:43], v[28:31], v[76:91]
    s_add_u32 m0, m0, 1024
    s_add_u32 s76, s76, 1
    buffer_load_dwordx4 v3, s[40:43], s80 offen lds
    v_mfma_f32_32x32x16_bf16 v[92:107], v[40:43], v[32:35], v[92:107]
    s_waitcnt lgkmcnt(0)
    v_mfma_f32_32x32x16_bf16 v[44:59], v[20:23], v[12:15], v[44:59]
    ds_read_b64_tr_b16 v[36:37], v8 offset:20480
    ds_read_b64_tr_b16 v[38:39], v8 offset:21504
    s_add_u32 m0, m0, 7168
    s_and_b32 s76, s76, 15
    buffer_load_dwordx4 v4, s[44:47], s81 offen lds
    v_mfma_f32_32x32x16_bf16 v[60:75], v[20:23], v[16:19], v[60:75]
    ds_read_b128 v[28:31], v7 offset:16384
    ds_read_b64_tr_b16 v[40:41], v9 offset:20480
    v_mfma_f32_32x32x16_bf16 v[76:91], v[24:27], v[12:15], v[76:91]
    ds_read_b64_tr_b16 v[42:43], v9 offset:21504
    ds_read_b128 v[32:35], v7 offset:18432
    s_add_u32 m0, m0, 1024
    s_nop 0
    buffer_load_dwordx4 v5, s[44:47], s81 offen lds
    v_mfma_f32_32x32x16_bf16 v[92:107], v[24:27], v[16:19], v[92:107]
    s_waitcnt lgkmcnt(0)
    v_mfma_f32_32x32x16_bf16 v[44:59], v[36:39], v[28:31], v[44:59]
    s_waitcnt vmcnt(9)
    s_barrier
    ds_read_b64_tr_b16 v[20:21], v8 offset:32768
    ds_read_b64_tr_b16 v[22:23], v8 offset:33792
    ds_read_b128 v[12:15], v6 offset:32768
    s_lshl_b32 s80, s76, 6
    s_mul_i32 s81, s76, 114688
    s_add_u32 s80, s80, s77
    s_add_u32 m0, s79, 16384
    s_add_u32 s81, s81, s78
    buffer_load_dwordx4 v2, s[40:43], s80 offen lds
    v_mfma_f32_32x32x16_bf16 v[60:75], v[36:39], v[32:35], v[60:75]
    ds_read_b64_tr_b16 v[24:25], v9 offset:32768
    ds_read_b64_tr_b16 v[26:27], v9 offset:33792
    ds_read_b128 v[16:19], v6 offset:34816
    v_mfma_f32_32x32x16_bf16 v[76:91], v[40:43], v[28:31], v[76:91]
    s_add_u32 m0, m0, 1024
    s_add_u32 s76, s76, 1
    buffer_load_dwordx4 v3, s[40:43], s80 offen lds
    v_mfma_f32_32x32x16_bf16 v[92:107], v[40:43], v[32:35], v[92:107]
    s_waitcnt lgkmcnt(0)
    v_mfma_f32_32x32x16_bf16 v[44:59], v[20:23], v[12:15], v[44:59]
    ds_read_b64_tr_b16 v[36:37], v8 offset:36864
    ds_read_b64_tr_b16 v[38:39], v8 offset:37888
    s_add_u32 m0, m0, 7168
    s_and_b32 s76, s76, 15
    buffer_load_dwordx4 v4, s[44:47], s81 offen lds
    v_mfma_f32_32x32x16_bf16 v[60:75], v[20:23], v[16:19], v[60:75]
    ds_read_b128 v[28:31], v7 offset:32768
    ds_read_b64_tr_b16 v[40:41], v9 offset:36864
    v_mfma_f32_32x32x16_bf16 v[76:91], v[24:27], v[12:15], v[76:91]
    ds_read_b64_tr_b16 v[42:43], v9 offset:37888
    ds_read_b128 v[32:35], v7 offset:34816
    s_add_u32 m0, m0, 1024
    s_nop 0
    buffer_load_dwordx4 v5, s[44:47], s81 offen lds
    v_mfma_f32_32x32x16_bf16 v[92:107], v[24:27], v[16:19], v[92:107]
    s_waitcnt lgkmcnt(0)
    v_mfma_f32_32x32x16_bf16 v[44:59], v[36:39], v[28:31], v[44:59]
    s_waitcnt vmcnt(9)
    s_barrier
    ds_read_b64_tr_b16 v[20:21], v8 offset:49152
    ds_read_b64_tr_b16 v[22:23], v8 offset:50176
    ds_read_b128 v[12:15], v6 offset:49152
    s_lshl_b32 s80, s76, 6
    s_mul_i32 s81, s76, 114688
    s_add_u32 s80, s80, s77
    s_add_u32 m0, s79, 32768
    s_add_u32 s81, s81, s78
    buffer_load_dwordx4 v2, s[40:43], s80 offen lds
    v_mfma_f32_32x32x16_bf16 v[60:75], v[36:39], v[32:35], v[60:75]
    ds_read_b64_tr_b16 v[24:25], v9 offset:49152
    ds_read_b64_tr_b16 v[26:27], v9 offset:50176
    ds_read_b128 v[16:19], v6 offset:51200
    v_mfma_f32_32x32x16_bf16 v[76:91], v[40:43], v[28:31], v[76:91]
    s_add_u32 m0, m0, 1024
    s_add_u32 s76, s76, 1
    buffer_load_dwordx4 v3, s[40:43], s80 offen lds
    v_mfma_f32_32x32x16_bf16 v[92:107], v[40:43], v[32:35], v[92:107]
    s_waitcnt lgkmcnt(0)
    v_mfma_f32_32x32x16_bf16 v[44:59], v[20:23], v[12:15], v[44:59]
    ds_read_b64_tr_b16 v[36:37], v8 offset:53248
    ds_read_b64_tr_b16 v[38:39], v8 offset:54272
    s_add_u32 m0, m0, 7168
    s_and_b32 s76, s76, 15
    buffer_load_dwordx4 v4, s[44:47], s81 offen lds
    v_mfma_f32_32x32x16_bf16 v[60:75], v[20:23], v[16:19], v[60:75]
    ds_read_b128 v[28:31], v7 offset:49152
    ds_read_b64_tr_b16 v[40:41], v9 offset:53248
    v_mfma_f32_32x32x16_bf16 v[76:91], v[24:27], v[12:15], v[76:91]
    ds_read_b64_tr_b16 v[42:43], v9 offset:54272
    ds_read_b128 v[32:35], v7 offset:51200
    s_add_u32 m0, m0, 1024
    s_nop 0
    buffer_load_dwordx4 v5, s[44:47], s81 offen lds
    v_mfma_f32_32x32x16_bf16 v[92:107], v[24:27], v[16:19], v[92:107]
    s_waitcnt lgkmcnt(0)
    v_mfma_f32_32x32x16_bf16 v[44:59], v[36:39], v[28:31], v[44:59]
    s_waitcnt vmcnt(8)
    s_barrier
    ds_read_b64_tr_b16 v[20:21], v8 offset:0
    ds_read_b64_tr_b16 v[22:23], v8 offset:1024
    ds_read_b128 v[12:15], v6 offset:0
    s_lshl_b32 s80, s76, 6
    s_mul_i32 s81, s76, 114688
    s_add_u32 s80, s80, s77
    s_add_u32 m0, s79, 49152
    s_add_u32 s81, s81, s78
    buffer_load_dwordx4 v2, s[40:43], s80 offen lds
    v_mfma_f32_32x32x16_bf16 v[60:75], v[36:39], v[32:35], v[60:75]
    ds_read_b64_tr_b16 v[24:25], v9 offset:0
    ds_read_b64_tr_b16 v[26:27], v9 offset:1024
    ds_read_b128 v[16:19], v6 offset:2048
    v_mfma_f32_32x32x16_bf16 v[76:91], v[40:43], v[28:31], v[76:91]
    s_add_u32 m0, m0, 1024
    s_add_u32 s76, s76, 1
    buffer_load_dwordx4 v3, s[40:43], s80 offen lds
    v_mfma_f32_32x32x16_bf16 v[92:107], v[40:43], v[32:35], v[92:107]
    s_waitcnt lgkmcnt(0)
    v_mfma_f32_32x32x16_bf16 v[44:59], v[20:23], v[12:15], v[44:59]
    ds_read_b64_tr_b16 v[36:37], v8 offset:4096
    ds_read_b64_tr_b16 v[38:39], v8 offset:5120
    s_add_u32 m0, m0, 7168
    s_and_b32 s76, s76, 15
    buffer_load_dwordx4 v4, s[44:47], s81 offen lds
    v_mfma_f32_32x32x16_bf16 v[60:75], v[20:23], v[16:19], v[60:75]
    ds_read_b128 v[28:31], v7 offset:0
    ds_read_b64_tr_b16 v[40:41], v9 offset:4096
    v_mfma_f32_32x32x16_bf16 v[76:91], v[24:27], v[12:15], v[76:91]
    ds_read_b64_tr_b16 v[42:43], v9 offset:5120
    ds_read_b128 v[32:35], v7 offset:2048
    s_add_u32 m0, m0, 1024
    s_nop 0
    buffer_load_dwordx4 v5, s[44:47], s81 offen lds
    v_mfma_f32_32x32x16_bf16 v[92:107], v[24:27], v[16:19], v[92:107]
    s_waitcnt lgkmcnt(0)
    v_mfma_f32_32x32x16_bf16 v[44:59], v[36:39], v[28:31], v[44:59]
    s_waitcnt vmcnt(8)
    s_barrier
    ds_read_b64_tr_b16 v[20:21], v8 offset:16384
    ds_read_b64_tr_b16 v[22:23], v8 offset:17408
    ds_read_b128 v[12:15], v6 offset:16384
    s_lshl_b32 s80, s76, 6
    s_mul_i32 s81, s76, 114688
    s_add_u32 s80, s80, s77
    s_add_u32 m0, s79, 0
    s_add_u32 s81, s81, s78
    buffer_load_dwordx4 v2, s[40:43], s80 offen lds
    v_mfma_f32_32x32x16_bf16 v[60:75], v[36:39], v[32:35], v[60:75]
    ds_read_b64_tr_b16 v[24:25], v9 offset:16384
    ds_read_b64_tr_b16 v[26:27], v9 offset:17408
    ds_read_b128 v[16:19], v6 offset:18432
    v_mfma_f32_32x32x16_bf16 v[76:91], v[40:43], v[28:31], v[76:91]
    s_add_u32 m0, m0, 1024
    s_add_u32 s76, s76, 1
    buffer_load_dwordx4 v3, s[40:43], s80 offen lds
    v_mfma_f32_32x32x16_bf16 v[92:107], v[40:43], v[32:35], v[92:107]
    s_waitcnt lgkmcnt(0)
    v_mfma_f32_32x32x16_bf16 v[44:59], v[20:23], v[12:15], v[44:59]
    ds_read_b64_tr_b16 v[36:37], v8 offset:20480
    ds_read_b64_tr_b16 v[38:39], v8 offset:21504
    s_add_u32 m0, m0, 7168
    s_and_b32 s76, s76, 15
    buffer_load_dwordx4 v4, s[44:47], s81 offen lds
    v_mfma_f32_32x32x16_bf16 v[60:75], v[20:23], v[16:19], v[60:75]
    ds_read_b128 v[28:31], v7 offset:16384
    ds_read_b64_tr_b16 v[40:41], v9 offset:20480
    v_mfma_f32_32x32x16_bf16 v[76:91], v[24:27], v[12:15], v[76:91]
    ds_read_b64_tr_b16 v[42:43], v9 offset:21504
    ds_read_b128 v[32:35], v7 offset:18432
    s_add_u32 m0, m0, 1024
    s_nop 0
    buffer_load_dwordx4 v5, s[44:47], s81 offen lds
    v_mfma_f32_32x32x16_bf16 v[92:107], v[24:27], v[16:19], v[92:107]
    s_waitcnt lgkmcnt(0)
    v_mfma_f32_32x32x16_bf16 v[44:59], v[36:39], v[28:31], v[44:59]
    s_waitcnt vmcnt(8)
    s_barrier
    ds_read_b64_tr_b16 v[20:21], v8 offset:32768
    ds_read_b64_tr_b16 v[22:23], v8 offset:33792
    ds_read_b128 v[12:15], v6 offset:32768
    s_lshl_b32 s80, s76, 6
    s_mul_i32 s81, s76, 114688
    s_add_u32 s80, s80, s77
    s_add_u32 m0, s79, 16384
    s_add_u32 s81, s81, s78
    buffer_load_dwordx4 v2, s[40:43], s80 offen lds
    v_mfma_f32_32x32x16_bf16 v[60:75], v[36:39], v[32:35], v[60:75]
    ds_read_b64_tr_b16 v[24:25], v9 offset:32768
    ds_read_b64_tr_b16 v[26:27], v9 offset:33792
    ds_read_b128 v[16:19], v6 offset:34816
    v_mfma_f32_32x32x16_bf16 v[76:91], v[40:43], v[28:31], v[76:91]
    s_add_u32 m0, m0, 1024
    s_add_u32 s76, s76, 1
    buffer_load_dwordx4 v3, s[40:43], s80 offen lds
    v_mfma_f32_32x32x16_bf16 v[92:107], v[40:43], v[32:35], v[92:107]
    s_waitcnt lgkmcnt(0)
    v_mfma_f32_32x32x16_bf16 v[44:59], v[20:23], v[12:15], v[44:59]
    ds_read_b64_tr_b16 v[36:37], v8 offset:36864
    ds_read_b64_tr_b16 v[38:39], v8 offset:37888
    s_add_u32 m0, m0, 7168
    s_and_b32 s76, s76, 15
    buffer_load_dwordx4 v4, s[44:47], s81 offen lds
    v_mfma_f32_32x32x16_bf16 v[60:75], v[20:23], v[16:19], v[60:75]
    ds_read_b128 v[28:31], v7 offset:32768
    ds_read_b64_tr_b16 v[40:41], v9 offset:36864
    v_mfma_f32_32x32x16_bf16 v[76:91], v[24:27], v[12:15], v[76:91]
    ds_read_b64_tr_b16 v[42:43], v9 offset:37888
    ds_read_b128 v[32:35], v7 offset:34816
    s_add_u32 m0, m0, 1024
    s_nop 0
    buffer_load_dwordx4 v5, s[44:47], s81 offen lds
    v_mfma_f32_32x32x16_bf16 v[92:107], v[24:27], v[16:19], v[92:107]
    s_waitcnt lgkmcnt(0)
    v_mfma_f32_32x32x16_bf16 v[44:59], v[36:39], v[28:31], v[44:59]
    s_waitcnt vmcnt(8)
    s_barrier
    ds_read_b64_tr_b16 v[20:21], v8 offset:49152
    ds_read_b64_tr_b16 v[22:23], v8 offset:50176
    ds_read_b128 v[12:15], v6 offset:49152
    s_lshl_b32 s80, s76, 6
    s_mul_i32 s81, s76, 114688
    s_add_u32 s80, s80, s77
    s_add_u32 m0, s79, 32768
    s_add_u32 s81, s81, s78
    buffer_load_dwordx4 v2, s[40:43], s80 offen lds
    v_mfma_f32_32x32x16_bf16 v[60:75], v[36:39], v[32:35], v[60:75]
    ds_read_b64_tr_b16 v[24:25], v9 offset:49152
    ds_read_b64_tr_b16 v[26:27], v9 offset:50176
    ds_read_b128 v[16:19], v6 offset:51200
    v_mfma_f32_32x32x16_bf16 v[76:91], v[40:43], v[28:31], v[76:91]
    s_add_u32 m0, m0, 1024
    s_add_u32 s76, s76, 1
    buffer_load_dwordx4 v3, s[40:43], s80 offen lds
    v_mfma_f32_32x32x16_bf16 v[92:107], v[40:43], v[32:35], v[92:107]
    s_waitcnt lgkmcnt(0)
    v_mfma_f32_32x32x16_bf16 v[44:59], v[20:23], v[12:15], v[44:59]
    ds_read_b64_tr_b16 v[36:37], v8 offset:53248
    ds_read_b64_tr_b16 v[38:39], v8 offset:54272
    s_add_u32 m0, m0, 7168
    s_and_b32 s76, s76, 15
    buffer_load_dwordx4 v4, s[44:47], s81 offen lds
    v_mfma_f32_32x32x16_bf16 v[60:75], v[20:23], v[16:19], v[60:75]
    ds_read_b128 v[28:31], v7 offset:49152
    ds_read_b64_tr_b16 v[40:41], v9 offset:53248
    v_mfma_f32_32x32x16_bf16 v[76:91], v[24:27], v[12:15], v[76:91]
    ds_read_b64_tr_b16 v[42:43], v9 offset:54272
    ds_read_b128 v[32:35], v7 offset:51200
    s_add_u32 m0, m0, 1024
    s_nop 0
    buffer_load_dwordx4 v5, s[44:47], s81 offen lds
    v_mfma_f32_32x32x16_bf16 v[92:107], v[24:27], v[16:19], v[92:107]
    s_waitcnt lgkmcnt(0)
    v_mfma_f32_32x32x16_bf16 v[44:59], v[36:39], v[28:31], v[44:59]
    s_waitcnt vmcnt(8)
    s_barrier
    ds_read_b64_tr_b16 v[20:21], v8 offset:0
    ds_read_b64_tr_b16 v[22:23], v8 offset:1024
    ds_read_b128 v[12:15], v6 offset:0
    s_lshl_b32 s80, s76, 6
    s_mul_i32 s81, s76, 114688
    s_add_u32 s80, s80, s77
    s_add_u32 m0, s79, 49152
    s_add_u32 s81, s81, s78
    buffer_load_dwordx4 v2, s[40:43], s80 offen lds
    v_mfma_f32_32x32x16_bf16 v[60:75], v[36:39], v[32:35], v[60:75]
    ds_read_b64_tr_b16 v[24:25], v9 offset:0
    ds_read_b64_tr_b16 v[26:27], v9 offset:1024
    ds_read_b128 v[16:19], v6 offset:2048
    v_mfma_f32_32x32x16_bf16 v[76:91], v[40:43], v[28:31], v[76:91]
    s_add_u32 m0, m0, 1024
    s_add_u32 s76, s76, 1
    buffer_load_dwordx4 v3, s[40:43], s80 offen lds
    v_mfma_f32_32x32x16_bf16 v[92:107], v[40:43], v[32:35], v[92:107]
    s_waitcnt lgkmcnt(0)
    v_mfma_f32_32x32x16_bf16 v[44:59], v[20:23], v[12:15], v[44:59]
    ds_read_b64_tr_b16 v[36:37], v8 offset:4096
    ds_read_b64_tr_b16 v[38:39], v8 offset:5120
    s_add_u32 m0, m0, 7168
    s_and_b32 s76, s76, 15
    buffer_load_dwordx4 v4, s[44:47], s81 offen lds
    v_mfma_f32_32x32x16_bf16 v[60:75], v[20:23], v[16:19], v[60:75]
    ds_read_b128 v[28:31], v7 offset:0
    ds_read_b64_tr_b16 v[40:41], v9 offset:4096
    v_mfma_f32_32x32x16_bf16 v[76:91], v[24:27], v[12:15], v[76:91]
    ds_read_b64_tr_b16 v[42:43], v9 offset:5120
    ds_read_b128 v[32:35], v7 offset:2048
    s_add_u32 m0, m0, 1024
    s_nop 0
    buffer_load_dwordx4 v5, s[44:47], s81 offen lds
    v_mfma_f32_32x32x16_bf16 v[92:107], v[24:27], v[16:19], v[92:107]
    s_waitcnt lgkmcnt(0)
    v_mfma_f32_32x32x16_bf16 v[44:59], v[36:39], v[28:31], v[44:59]
    s_waitcnt vmcnt(8)
    s_barrier
    ds_read_b64_tr_b16 v[20:21], v8 offset:16384
    ds_read_b64_tr_b16 v[22:23], v8 offset:17408
    ds_read_b128 v[12:15], v6 offset:16384
    s_lshl_b32 s80, s76, 6
    s_mul_i32 s81, s76, 114688
    s_add_u32 s80, s80, s77
    s_add_u32 m0, s79, 0
    s_add_u32 s81, s81, s78
    buffer_load_dwordx4 v2, s[40:43], s80 offen lds
    v_mfma_f32_32x32x16_bf16 v[60:75], v[36:39], v[32:35], v[60:75]
    ds_read_b64_tr_b16 v[24:25], v9 offset:16384
    ds_read_b64_tr_b16 v[26:27], v9 offset:17408
    ds_read_b128 v[16:19], v6 offset:18432
    v_mfma_f32_32x32x16_bf16 v[76:91], v[40:43], v[28:31], v[76:91]
    s_add_u32 m0, m0, 1024
    s_add_u32 s76, s76, 1
    buffer_load_dwordx4 v3, s[40:43], s80 offen lds
    v_mfma_f32_32x32x16_bf16 v[92:107], v[40:43], v[32:35], v[92:107]
    s_waitcnt lgkmcnt(0)
    v_mfma_f32_32x32x16_bf16 v[44:59], v[20:23], v[12:15], v[44:59]
    ds_read_b64_tr_b16 v[36:37], v8 offset:20480
    ds_read_b64_tr_b16 v[38:39], v8 offset:21504
    s_add_u32 m0, m0, 7168
    s_and_b32 s76, s76, 15
    buffer_load_dwordx4 v4, s[44:47], s81 offen lds
    v_mfma_f32_32x32x16_bf16 v[60:75], v[20:23], v[16:19], v[60:75]
    ds_read_b128 v[28:31], v7 offset:16384
    ds_read_b64_tr_b16 v[40:41], v9 offset:20480
    v_mfma_f32_32x32x16_bf16 v[76:91], v[24:27], v[12:15], v[76:91]
    ds_read_b64_tr_b16 v[42:43], v9 offset:21504
    ds_read_b128 v[32:35], v7 offset:18432
    s_add_u32 m0, m0, 1024
    s_nop 0
    buffer_load_dwordx4 v5, s[44:47], s81 offen lds
    v_mfma_f32_32x32x16_bf16 v[92:107], v[24:27], v[16:19], v[92:107]
    s_waitcnt lgkmcnt(0)
    v_mfma_f32_32x32x16_bf16 v[44:59], v[36:39], v[28:31], v[44:59]
    s_waitcnt vmcnt(8)
    s_barrier
    ds_read_b64_tr_b16 v[20:21], v8 offset:32768
    ds_read_b64_tr_b16 v[22:23], v8 offset:33792
    ds_read_b128 v[12:15], v6 offset:32768
    s_lshl_b32 s80, s76, 6
    s_mul_i32 s81, s76, 114688
    s_add_u32 s80, s80, s77
    s_add_u32 m0, s79, 16384
    s_add_u32 s81, s81, s78
    buffer_load_dwordx4 v2, s[40:43], s80 offen lds
    v_mfma_f32_32x32x16_bf16 v[60:75], v[36:39], v[32:35], v[60:75]
    ds_read_b64_tr_b16 v[24:25], v9 offset:32768
    ds_read_b64_tr_b16 v[26:27], v9 offset:33792
    ds_read_b128 v[16:19], v6 offset:34816
    v_mfma_f32_32x32x16_bf16 v[76:91], v[40:43], v[28:31], v[76:91]
    s_add_u32 m0, m0, 1024
    s_add_u32 s76, s76, 1
    buffer_load_dwordx4 v3, s[40:43], s80 offen lds
    v_mfma_f32_32x32x16_bf16 v[92:107], v[40:43], v[32:35], v[92:107]
    s_waitcnt lgkmcnt(0)
    v_mfma_f32_32x32x16_bf16 v[44:59], v[20:23], v[12:15], v[44:59]
    ds_read_b64_tr_b16 v[36:37], v8 offset:36864
    ds_read_b64_tr_b16 v[38:39], v8 offset:37888
    s_add_u32 m0, m0, 7168
    s_and_b32 s76, s76, 15
    buffer_load_dwordx4 v4, s[44:47], s81 offen lds
    v_mfma_f32_32x32x16_bf16 v[60:75], v[20:23], v[16:19], v[60:75]
    ds_read_b128 v[28:31], v7 offset:32768
    ds_read_b64_tr_b16 v[40:41], v9 offset:36864
    v_mfma_f32_32x32x16_bf16 v[76:91], v[24:27], v[12:15], v[76:91]
    ds_read_b64_tr_b16 v[42:43], v9 offset:37888
    ds_read_b128 v[32:35], v7 offset:34816
    s_add_u32 m0, m0, 1024
    s_nop 0
    buffer_load_dwordx4 v5, s[44:47], s81 offen lds
    v_mfma_f32_32x32x16_bf16 v[92:107], v[24:27], v[16:19], v[92:107]
    s_waitcnt lgkmcnt(0)
    v_mfma_f32_32x32x16_bf16 v[44:59], v[36:39], v[28:31], v[44:59]
    s_waitcnt vmcnt(8)
    s_barrier
    ds_read_b64_tr_b16 v[20:21], v8 offset:49152
    ds_read_b64_tr_b16 v[22:23], v8 offset:50176
    ds_read_b128 v[12:15], v6 offset:49152
    s_lshl_b32 s80, s76, 6
    s_mul_i32 s81, s76, 114688
    s_add_u32 s80, s80, s77
    s_add_u32 m0, s79, 32768
    s_add_u32 s81, s81, s78
    buffer_load_dwordx4 v2, s[40:43], s80 offen lds
    v_mfma_f32_32x32x16_bf16 v[60:75], v[36:39], v[32:35], v[60:75]
    ds_read_b64_tr_b16 v[24:25], v9 offset:49152
    ds_read_b64_tr_b16 v[26:27], v9 offset:50176
    ds_read_b128 v[16:19], v6 offset:51200
    v_mfma_f32_32x32x16_bf16 v[76:91], v[40:43], v[28:31], v[76:91]
    s_add_u32 m0, m0, 1024
    s_add_u32 s76, s76, 1
    buffer_load_dwordx4 v3, s[40:43], s80 offen lds
    v_mfma_f32_32x32x16_bf16 v[92:107], v[40:43], v[32:35], v[92:107]
    s_waitcnt lgkmcnt(0)
    v_mfma_f32_32x32x16_bf16 v[44:59], v[20:23], v[12:15], v[44:59]
    ds_read_b64_tr_b16 v[36:37], v8 offset:53248
    ds_read_b64_tr_b16 v[38:39], v8 offset:54272
    s_add_u32 m0, m0, 7168
    s_and_b32 s76, s76, 15
    buffer_load_dwordx4 v4, s[44:47], s81 offen lds
    v_mfma_f32_32x32x16_bf16 v[60:75], v[20:23], v[16:19], v[60:75]
    ds_read_b128 v[28:31], v7 offset:49152
    ds_read_b64_tr_b16 v[40:41], v9 offset:53248
    v_mfma_f32_32x32x16_bf16 v[76:91], v[24:27], v[12:15], v[76:91]
    ds_read_b64_tr_b16 v[42:43], v9 offset:54272
    ds_read_b128 v[32:35], v7 offset:51200
    s_add_u32 m0, m0, 1024
    s_nop 0
    buffer_load_dwordx4 v5, s[44:47], s81 offen lds
    v_mfma_f32_32x32x16_bf16 v[92:107], v[24:27], v[16:19], v[92:107]
    s_waitcnt lgkmcnt(0)
    v_mfma_f32_32x32x16_bf16 v[44:59], v[36:39], v[28:31], v[44:59]
    s_waitcnt vmcnt(8)
    s_barrier
    ds_read_b64_tr_b16 v[20:21], v8 offset:0
    ds_read_b64_tr_b16 v[22:23], v8 offset:1024
    ds_read_b128 v[12:15], v6 offset:0
    s_lshl_b32 s80, s76, 6
    s_mul_i32 s81, s76, 114688
    s_add_u32 s80, s80, s77
    s_add_u32 m0, s79, 49152
    s_add_u32 s81, s81, s78
    buffer_load_dwordx4 v2, s[40:43], s80 offen lds
    v_mfma_f32_32x32x16_bf16 v[60:75], v[36:39], v[32:35], v[60:75]
    ds_read_b64_tr_b16 v[24:25], v9 offset:0
    ds_read_b64_tr_b16 v[26:27], v9 offset:1024
    ds_read_b128 v[16:19], v6 offset:2048
    v_mfma_f32_32x32x16_bf16 v[76:91], v[40:43], v[28:31], v[76:91]
    s_add_u32 m0, m0, 1024
    s_add_u32 s76, s76, 1
    buffer_load_dwordx4 v3, s[40:43], s80 offen lds
    v_mfma_f32_32x32x16_bf16 v[92:107], v[40:43], v[32:35], v[92:107]
    s_waitcnt lgkmcnt(0)
    v_mfma_f32_32x32x16_bf16 v[44:59], v[20:23], v[12:15], v[44:59]
    ds_read_b64_tr_b16 v[36:37], v8 offset:4096
    ds_read_b64_tr_b16 v[38:39], v8 offset:5120
    s_add_u32 m0, m0, 7168
    s_and_b32 s76, s76, 15
    buffer_load_dwordx4 v4, s[44:47], s81 offen lds
    v_mfma_f32_32x32x16_bf16 v[60:75], v[20:23], v[16:19], v[60:75]
    ds_read_b128 v[28:31], v7 offset:0
    ds_read_b64_tr_b16 v[40:41], v9 offset:4096
    v_mfma_f32_32x32x16_bf16 v[76:91], v[24:27], v[12:15], v[76:91]
    ds_read_b64_tr_b16 v[42:43], v9 offset:5120
    ds_read_b128 v[32:35], v7 offset:2048
    s_add_u32 m0, m0, 1024
    s_nop 0
    buffer_load_dwordx4 v5, s[44:47], s81 offen lds
    v_mfma_f32_32x32x16_bf16 v[92:107], v[24:27], v[16:19], v[92:107]
    s_waitcnt lgkmcnt(0)
    v_mfma_f32_32x32x16_bf16 v[44:59], v[36:39], v[28:31], v[44:59]
    s_waitcnt vmcnt(8)
    s_barrier
    ds_read_b64_tr_b16 v[20:21], v8 offset:16384
    ds_read_b64_tr_b16 v[22:23], v8 offset:17408
    ds_read_b128 v[12:15], v6 offset:16384
    v_mfma_f32_32x32x16_bf16 v[60:75], v[36:39], v[32:35], v[60:75]
    ds_read_b64_tr_b16 v[24:25], v9 offset:16384
    ds_read_b64_tr_b16 v[26:27], v9 offset:17408
    ds_read_b128 v[16:19], v6 offset:18432
    v_mfma_f32_32x32x16_bf16 v[76:91], v[40:43], v[28:31], v[76:91]
    v_mfma_f32_32x32x16_bf16 v[92:107], v[40:43], v[32:35], v[92:107]
    s_waitcnt lgkmcnt(0)
    v_mfma_f32_32x32x16_bf16 v[44:59], v[20:23], v[12:15], v[44:59]
    ds_read_b64_tr_b16 v[36:37], v8 offset:20480
    ds_read_b64_tr_b16 v[38:39], v8 offset:21504
    v_mfma_f32_32x32x16_bf16 v[60:75], v[20:23], v[16:19], v[60:75]
    ds_read_b128 v[28:31], v7 offset:16384
    ds_read_b64_tr_b16 v[40:41], v9 offset:20480
    v_mfma_f32_32x32x16_bf16 v[76:91], v[24:27], v[12:15], v[76:91]
    ds_read_b64_tr_b16 v[42:43], v9 offset:21504
    ds_read_b128 v[32:35], v7 offset:18432
    v_mfma_f32_32x32x16_bf16 v[92:107], v[24:27], v[16:19], v[92:107]
    s_waitcnt lgkmcnt(0)
    v_mfma_f32_32x32x16_bf16 v[44:59], v[36:39], v[28:31], v[44:59]
    s_waitcnt vmcnt(4)
    s_barrier
    ds_read_b64_tr_b16 v[20:21], v8 offset:32768
    ds_read_b64_tr_b16 v[22:23], v8 offset:33792
    ds_read_b128 v[12:15], v6 offset:32768
    v_mfma_f32_32x32x16_bf16 v[60:75], v[36:39], v[32:35], v[60:75]
    ds_read_b64_tr_b16 v[24:25], v9 offset:32768
    ds_read_b64_tr_b16 v[26:27], v9 offset:33792
    ds_read_b128 v[16:19], v6 offset:34816
    v_mfma_f32_32x32x16_bf16 v[76:91], v[40:43], v[28:31], v[76:91]
    v_mfma_f32_32x32x16_bf16 v[92:107], v[40:43], v[32:35], v[92:107]
    s_waitcnt lgkmcnt(0)
    v_mfma_f32_32x32x16_bf16 v[44:59], v[20:23], v[12:15], v[44:59]
    ds_read_b64_tr_b16 v[36:37], v8 offset:36864
    ds_read_b64_tr_b16 v[38:39], v8 offset:37888
    v_mfma_f32_32x32x16_bf16 v[60:75], v[20:23], v[16:19], v[60:75]
    ds_read_b128 v[28:31], v7 offset:32768
    ds_read_b64_tr_b16 v[40:41], v9 offset:36864
    v_mfma_f32_32x32x16_bf16 v[76:91], v[24:27], v[12:15], v[76:91]
    ds_read_b64_tr_b16 v[42:43], v9 offset:37888
    ds_read_b128 v[32:35], v7 offset:34816
    v_mfma_f32_32x32x16_bf16 v[92:107], v[24:27], v[16:19], v[92:107]
    s_waitcnt lgkmcnt(0)
    v_mfma_f32_32x32x16_bf16 v[44:59], v[36:39], v[28:31], v[44:59]
    s_waitcnt vmcnt(0)
    s_barrier
    ds_read_b64_tr_b16 v[20:21], v8 offset:49152
    ds_read_b64_tr_b16 v[22:23], v8 offset:50176
    ds_read_b128 v[12:15], v6 offset:49152
    v_mfma_f32_32x32x16_bf16 v[60:75], v[36:39], v[32:35], v[60:75]
    ds_read_b64_tr_b16 v[24:25], v9 offset:49152
    ds_read_b64_tr_b16 v[26:27], v9 offset:50176
    ds_read_b128 v[16:19], v6 offset:51200
    v_mfma_f32_32x32x16_bf16 v[76:91], v[40:43], v[28:31], v[76:91]
    v_mfma_f32_32x32x16_bf16 v[92:107], v[40:43], v[32:35], v[92:107]
    s_waitcnt lgkmcnt(0)
    v_mfma_f32_32x32x16_bf16 v[44:59], v[20:23], v[12:15], v[44:59]
    ds_read_b64_tr_b16 v[36:37], v8 offset:53248
    ds_read_b64_tr_b16 v[38:39], v8 offset:54272
    v_mfma_f32_32x32x16_bf16 v[60:75], v[20:23], v[16:19], v[60:75]
    ds_read_b128 v[28:31], v7 offset:49152
    ds_read_b64_tr_b16 v[40:41], v9 offset:53248
    v_mfma_f32_32x32x16_bf16 v[76:91], v[24:27], v[12:15], v[76:91]
    ds_read_b64_tr_b16 v[42:43], v9 offset:54272
    ds_read_b128 v[32:35], v7 offset:51200
    v_mfma_f32_32x32x16_bf16 v[92:107], v[24:27], v[16:19], v[92:107]
    s_waitcnt lgkmcnt(0)
    v_mfma_f32_32x32x16_bf16 v[44:59], v[36:39], v[28:31], v[44:59]
    v_mfma_f32_32x32x16_bf16 v[60:75], v[36:39], v[32:35], v[60:75]
    v_mfma_f32_32x32x16_bf16 v[76:91], v[40:43], v[28:31], v[76:91]
    v_mfma_f32_32x32x16_bf16 v[92:107], v[40:43], v[32:35], v[92:107]
    s_setprio 0
    v_mov_b32 v164, 160768
    ds_read_b32 v165, v164
    v_and_b32 v10, 31, v1
    v_lshrrev_b32 v11, 5, v1
    s_lshl_b32 s68, s86, 9
    s_add_u32 s68, s68, 0
    v_lshlrev_b32 v166, 3, v10
    v_add_u32 v166, s68, v166
    ds_read_b64 v[140:141], v166
    ds_read_b64 v[142:143], v166 offset:256
    s_lshl_b32 s68, s87, 8
    s_add_u32 s68, s68, 1024
    v_lshlrev_b32 v167, 4, v11
    v_add_u32 v167, s68, v167
    ds_read_b128 v[108:111], v167 offset:0
    ds_read_b128 v[112:115], v167 offset:32
    ds_read_b128 v[116:119], v167 offset:64
    ds_read_b128 v[120:123], v167 offset:96
    ds_read_b128 v[124:127], v167 offset:128
    ds_read_b128 v[128:131], v167 offset:160
    ds_read_b128 v[132:135], v167 offset:192
    ds_read_b128 v[136:139], v167 offset:224
    s_lshl_b32 s68, s64, 1
    s_add_u32 s68, s68, s86
    s_waitcnt lgkmcnt(0)
    v_readfirstlane_b32 s67, v165
    v_lshlrev_b32 v10, 4, v10
    v_lshl_add_u32 v160, v11, 10, v10
    v_add_u32 v161, 4096, v160
    s_mul_i32 s68, s68, 229376
    s_lshl_b32 s69, s65, 14
    s_add_u32 s68, s68, s69
    s_lshl_b32 s69, s87, 13
    s_add_u32 s68, s68, s69
    s_add_u32 s80, s68, 0
    s_mov_b32 s69, 0xbfb8aa3b
    v_mul_f32 v141, s69, v141
    v_mul_f32 v143, s69, v143
    v_pk_fma_f32 v[44:45], v[108:109], v[140:141], v[44:45] op_sel_hi:[1,0,1] neg_lo:[0,1,0] neg_hi:[0,1,0]
    v_pk_fma_f32 v[46:47], v[110:111], v[140:141], v[46:47] op_sel_hi:[1,0,1] neg_lo:[0,1,0] neg_hi:[0,1,0]
    v_pk_fma_f32 v[48:49], v[112:113], v[140:141], v[48:49] op_sel_hi:[1,0,1] neg_lo:[0,1,0] neg_hi:[0,1,0]
    v_pk_fma_f32 v[50:51], v[114:115], v[140:141], v[50:51] op_sel_hi:[1,0,1] neg_lo:[0,1,0] neg_hi:[0,1,0]
    v_pk_mul_f32 v[44:45], v[44:45], v[140:141] op_sel:[0,1] op_sel_hi:[1,1]
    v_pk_mul_f32 v[46:47], v[46:47], v[140:141] op_sel:[0,1] op_sel_hi:[1,1]
    v_pk_mul_f32 v[48:49], v[48:49], v[140:141] op_sel:[0,1] op_sel_hi:[1,1]
    v_pk_mul_f32 v[50:51], v[50:51], v[140:141] op_sel:[0,1] op_sel_hi:[1,1]
    v_exp_f32 v164, v44
    v_exp_f32 v165, v45
    v_exp_f32 v166, v46
    v_exp_f32 v167, v47
    v_exp_f32 v168, v48
    v_exp_f32 v169, v49
    v_exp_f32 v170, v50
    v_exp_f32 v171, v51
    v_pk_add_f32 v[164:165], v[164:165], 1.0 op_sel_hi:[1,0]
    v_pk_add_f32 v[166:167], v[166:167], 1.0 op_sel_hi:[1,0]
    v_pk_add_f32 v[168:169], v[168:169], 1.0 op_sel_hi:[1,0]
    v_pk_add_f32 v[170:171], v[170:171], 1.0 op_sel_hi:[1,0]
    v_rcp_f32 v164, v164
    v_rcp_f32 v165, v165
    v_rcp_f32 v166, v166
    v_rcp_f32 v167, v167
    v_rcp_f32 v168, v168
    v_rcp_f32 v169, v169
    v_rcp_f32 v170, v170
    v_rcp_f32 v171, v171
    v_pk_mul_f32 v[44:45], v[44:45], v[164:165]
    v_pk_mul_f32 v[46:47], v[46:47], v[166:167]
    v_pk_mul_f32 v[48:49], v[48:49], v[168:169]
    v_pk_mul_f32 v[50:51], v[50:51], v[170:171]
    v_cvt_pk_bf16_f32 v144, v44, v45
    v_cvt_pk_bf16_f32 v145, v46, v47
    v_cvt_pk_bf16_f32 v146, v48, v49
    v_cvt_pk_bf16_f32 v147, v50, v51
    s_nop 0
    v_permlane32_swap_b32 v144, v146
    v_permlane32_swap_b32 v145, v147
    buffer_store_dwordx4 v[144:147], v160, s[52:55], s80 offen offset:0 sc1
    v_pk_fma_f32 v[52:53], v[116:117], v[140:141], v[52:53] op_sel_hi:[1,0,1] neg_lo:[0,1,0] neg_hi:[0,1,0]
    v_pk_fma_f32 v[54:55], v[118:119], v[140:141], v[54:55] op_sel_hi:[1,0,1] neg_lo:[0,1,0] neg_hi:[0,1,0]
    v_pk_fma_f32 v[56:57], v[120:121], v[140:141], v[56:57] op_sel_hi:[1,0,1] neg_lo:[0,1,0] neg_hi:[0,1,0]
    v_pk_fma_f32 v[58:59], v[122:123], v[140:141], v[58:59] op_sel_hi:[1,0,1] neg_lo:[0,1,0] neg_hi:[0,1,0]
    v_pk_mul_f32 v[52:53], v[52:53], v[140:141] op_sel:[0,1] op_sel_hi:[1,1]
    v_pk_mul_f32 v[54:55], v[54:55], v[140:141] op_sel:[0,1] op_sel_hi:[1,1]
    v_pk_mul_f32 v[56:57], v[56:57], v[140:141] op_sel:[0,1] op_sel_hi:[1,1]
    v_pk_mul_f32 v[58:59], v[58:59], v[140:141] op_sel:[0,1] op_sel_hi:[1,1]
    v_exp_f32 v164, v52
    v_exp_f32 v165, v53
    v_exp_f32 v166, v54
    v_exp_f32 v167, v55
    v_exp_f32 v168, v56
    v_exp_f32 v169, v57
    v_exp_f32 v170, v58
    v_exp_f32 v171, v59
    v_pk_add_f32 v[164:165], v[164:165], 1.0 op_sel_hi:[1,0]
    v_pk_add_f32 v[166:167], v[166:167], 1.0 op_sel_hi:[1,0]
    v_pk_add_f32 v[168:169], v[168:169], 1.0 op_sel_hi:[1,0]
    v_pk_add_f32 v[170:171], v[170:171], 1.0 op_sel_hi:[1,0]
    v_rcp_f32 v164, v164
    v_rcp_f32 v165, v165
    v_rcp_f32 v166, v166
    v_rcp_f32 v167, v167
    v_rcp_f32 v168, v168
    v_rcp_f32 v169, v169
    v_rcp_f32 v170, v170
    v_rcp_f32 v171, v171
    v_pk_mul_f32 v[52:53], v[52:53], v[164:165]
    v_pk_mul_f32 v[54:55], v[54:55], v[166:167]
    v_pk_mul_f32 v[56:57], v[56:57], v[168:169]
    v_pk_mul_f32 v[58:59], v[58:59], v[170:171]
    v_cvt_pk_bf16_f32 v148, v52, v53
    v_cvt_pk_bf16_f32 v149, v54, v55
    v_cvt_pk_bf16_f32 v150, v56, v57
    v_cvt_pk_bf16_f32 v151, v58, v59
    s_nop 0
    v_permlane32_swap_b32 v148, v150
    v_permlane32_swap_b32 v149, v151
    buffer_store_dwordx4 v[148:151], v160, s[52:55], s80 offen offset:2048 sc1
    v_pk_fma_f32 v[60:61], v[108:109], v[142:143], v[60:61] op_sel_hi:[1,0,1] neg_lo:[0,1,0] neg_hi:[0,1,0]
    v_pk_fma_f32 v[62:63], v[110:111], v[142:143], v[62:63] op_sel_hi:[1,0,1] neg_lo:[0,1,0] neg_hi:[0,1,0]
    v_pk_fma_f32 v[64:65], v[112:113], v[142:143], v[64:65] op_sel_hi:[1,0,1] neg_lo:[0,1,0] neg_hi:[0,1,0]
    v_pk_fma_f32 v[66:67], v[114:115], v[142:143], v[66:67] op_sel_hi:[1,0,1] neg_lo:[0,1,0] neg_hi:[0,1,0]
    v_pk_mul_f32 v[60:61], v[60:61], v[142:143] op_sel:[0,1] op_sel_hi:[1,1]
    v_pk_mul_f32 v[62:63], v[62:63], v[142:143] op_sel:[0,1] op_sel_hi:[1,1]
    v_pk_mul_f32 v[64:65], v[64:65], v[142:143] op_sel:[0,1] op_sel_hi:[1,1]
    v_pk_mul_f32 v[66:67], v[66:67], v[142:143] op_sel:[0,1] op_sel_hi:[1,1]
    v_exp_f32 v164, v60
    v_exp_f32 v165, v61
    v_exp_f32 v166, v62
    v_exp_f32 v167, v63
    v_exp_f32 v168, v64
    v_exp_f32 v169, v65
    v_exp_f32 v170, v66
    v_exp_f32 v171, v67
    v_pk_add_f32 v[164:165], v[164:165], 1.0 op_sel_hi:[1,0]
    v_pk_add_f32 v[166:167], v[166:167], 1.0 op_sel_hi:[1,0]
    v_pk_add_f32 v[168:169], v[168:169], 1.0 op_sel_hi:[1,0]
    v_pk_add_f32 v[170:171], v[170:171], 1.0 op_sel_hi:[1,0]
    v_rcp_f32 v164, v164
    v_rcp_f32 v165, v165
    v_rcp_f32 v166, v166
    v_rcp_f32 v167, v167
    v_rcp_f32 v168, v168
    v_rcp_f32 v169, v169
    v_rcp_f32 v170, v170
    v_rcp_f32 v171, v171
    v_pk_mul_f32 v[60:61], v[60:61], v[164:165]
    v_pk_mul_f32 v[62:63], v[62:63], v[166:167]
    v_pk_mul_f32 v[64:65], v[64:65], v[168:169]
    v_pk_mul_f32 v[66:67], v[66:67], v[170:171]
    v_cvt_pk_bf16_f32 v152, v60, v61
    v_cvt_pk_bf16_f32 v153, v62, v63
    v_cvt_pk_bf16_f32 v154, v64, v65
    v_cvt_pk_bf16_f32 v155, v66, v67
    s_nop 0
    v_permlane32_swap_b32 v152, v154
    v_permlane32_swap_b32 v153, v155
    buffer_store_dwordx4 v[152:155], v160, s[52:55], s80 offen offset:512 sc1
    v_pk_fma_f32 v[68:69], v[116:117], v[142:143], v[68:69] op_sel_hi:[1,0,1] neg_lo:[0,1,0] neg_hi:[0,1,0]
    v_pk_fma_f32 v[70:71], v[118:119], v[142:143], v[70:71] op_sel_hi:[1,0,1] neg_lo:[0,1,0] neg_hi:[0,1,0]
    v_pk_fma_f32 v[72:73], v[120:121], v[142:143], v[72:73] op_sel_hi:[1,0,1] neg_lo:[0,1,0] neg_hi:[0,1,0]
    v_pk_fma_f32 v[74:75], v[122:123], v[142:143], v[74:75] op_sel_hi:[1,0,1] neg_lo:[0,1,0] neg_hi:[0,1,0]
    v_pk_mul_f32 v[68:69], v[68:69], v[142:143] op_sel:[0,1] op_sel_hi:[1,1]
    v_pk_mul_f32 v[70:71], v[70:71], v[142:143] op_sel:[0,1] op_sel_hi:[1,1]
    v_pk_mul_f32 v[72:73], v[72:73], v[142:143] op_sel:[0,1] op_sel_hi:[1,1]
    v_pk_mul_f32 v[74:75], v[74:75], v[142:143] op_sel:[0,1] op_sel_hi:[1,1]
    v_exp_f32 v164, v68
    v_exp_f32 v165, v69
    v_exp_f32 v166, v70
    v_exp_f32 v167, v71
    v_exp_f32 v168, v72
    v_exp_f32 v169, v73
    v_exp_f32 v170, v74
    v_exp_f32 v171, v75
    v_pk_add_f32 v[164:165], v[164:165], 1.0 op_sel_hi:[1,0]
    v_pk_add_f32 v[166:167], v[166:167], 1.0 op_sel_hi:[1,0]
    v_pk_add_f32 v[168:169], v[168:169], 1.0 op_sel_hi:[1,0]
    v_pk_add_f32 v[170:171], v[170:171], 1.0 op_sel_hi:[1,0]
    v_rcp_f32 v164, v164
    v_rcp_f32 v165, v165
    v_rcp_f32 v166, v166
    v_rcp_f32 v167, v167
    v_rcp_f32 v168, v168
    v_rcp_f32 v169, v169
    v_rcp_f32 v170, v170
    v_rcp_f32 v171, v171
    v_pk_mul_f32 v[68:69], v[68:69], v[164:165]
    v_pk_mul_f32 v[70:71], v[70:71], v[166:167]
    v_pk_mul_f32 v[72:73], v[72:73], v[168:169]
    v_pk_mul_f32 v[74:75], v[74:75], v[170:171]
    v_cvt_pk_bf16_f32 v156, v68, v69
    v_cvt_pk_bf16_f32 v157, v70, v71
    v_cvt_pk_bf16_f32 v158, v72, v73
    v_cvt_pk_bf16_f32 v159, v74, v75
    s_nop 0
    v_permlane32_swap_b32 v156, v158
    v_permlane32_swap_b32 v157, v159
    buffer_store_dwordx4 v[156:159], v160, s[52:55], s80 offen offset:2560 sc1
    v_pk_fma_f32 v[76:77], v[124:125], v[140:141], v[76:77] op_sel_hi:[1,0,1] neg_lo:[0,1,0] neg_hi:[0,1,0]
    v_pk_fma_f32 v[78:79], v[126:127], v[140:141], v[78:79] op_sel_hi:[1,0,1] neg_lo:[0,1,0] neg_hi:[0,1,0]
    v_pk_fma_f32 v[80:81], v[128:129], v[140:141], v[80:81] op_sel_hi:[1,0,1] neg_lo:[0,1,0] neg_hi:[0,1,0]
    v_pk_fma_f32 v[82:83], v[130:131], v[140:141], v[82:83] op_sel_hi:[1,0,1] neg_lo:[0,1,0] neg_hi:[0,1,0]
    v_pk_mul_f32 v[76:77], v[76:77], v[140:141] op_sel:[0,1] op_sel_hi:[1,1]
    v_pk_mul_f32 v[78:79], v[78:79], v[140:141] op_sel:[0,1] op_sel_hi:[1,1]
    v_pk_mul_f32 v[80:81], v[80:81], v[140:141] op_sel:[0,1] op_sel_hi:[1,1]
    v_pk_mul_f32 v[82:83], v[82:83], v[140:141] op_sel:[0,1] op_sel_hi:[1,1]
    v_exp_f32 v164, v76
    v_exp_f32 v165, v77
    v_exp_f32 v166, v78
    v_exp_f32 v167, v79
    v_exp_f32 v168, v80
    v_exp_f32 v169, v81
    v_exp_f32 v170, v82
    v_exp_f32 v171, v83
    v_pk_add_f32 v[164:165], v[164:165], 1.0 op_sel_hi:[1,0]
    v_pk_add_f32 v[166:167], v[166:167], 1.0 op_sel_hi:[1,0]
    v_pk_add_f32 v[168:169], v[168:169], 1.0 op_sel_hi:[1,0]
    v_pk_add_f32 v[170:171], v[170:171], 1.0 op_sel_hi:[1,0]
    v_rcp_f32 v164, v164
    v_rcp_f32 v165, v165
    v_rcp_f32 v166, v166
    v_rcp_f32 v167, v167
    v_rcp_f32 v168, v168
    v_rcp_f32 v169, v169
    v_rcp_f32 v170, v170
    v_rcp_f32 v171, v171
    v_pk_mul_f32 v[76:77], v[76:77], v[164:165]
    v_pk_mul_f32 v[78:79], v[78:79], v[166:167]
    v_pk_mul_f32 v[80:81], v[80:81], v[168:169]
    v_pk_mul_f32 v[82:83], v[82:83], v[170:171]
    v_cvt_pk_bf16_f32 v144, v76, v77
    v_cvt_pk_bf16_f32 v145, v78, v79
    v_cvt_pk_bf16_f32 v146, v80, v81
    v_cvt_pk_bf16_f32 v147, v82, v83
    s_nop 0
    v_permlane32_swap_b32 v144, v146
    v_permlane32_swap_b32 v145, v147
    buffer_store_dwordx4 v[144:147], v161, s[52:55], s80 offen offset:0 sc1
    v_pk_fma_f32 v[84:85], v[132:133], v[140:141], v[84:85] op_sel_hi:[1,0,1] neg_lo:[0,1,0] neg_hi:[0,1,0]
    v_pk_fma_f32 v[86:87], v[134:135], v[140:141], v[86:87] op_sel_hi:[1,0,1] neg_lo:[0,1,0] neg_hi:[0,1,0]
    v_pk_fma_f32 v[88:89], v[136:137], v[140:141], v[88:89] op_sel_hi:[1,0,1] neg_lo:[0,1,0] neg_hi:[0,1,0]
    v_pk_fma_f32 v[90:91], v[138:139], v[140:141], v[90:91] op_sel_hi:[1,0,1] neg_lo:[0,1,0] neg_hi:[0,1,0]
    v_pk_mul_f32 v[84:85], v[84:85], v[140:141] op_sel:[0,1] op_sel_hi:[1,1]
    v_pk_mul_f32 v[86:87], v[86:87], v[140:141] op_sel:[0,1] op_sel_hi:[1,1]
    v_pk_mul_f32 v[88:89], v[88:89], v[140:141] op_sel:[0,1] op_sel_hi:[1,1]
    v_pk_mul_f32 v[90:91], v[90:91], v[140:141] op_sel:[0,1] op_sel_hi:[1,1]
    v_exp_f32 v164, v84
    v_exp_f32 v165, v85
    v_exp_f32 v166, v86
    v_exp_f32 v167, v87
    v_exp_f32 v168, v88
    v_exp_f32 v169, v89
    v_exp_f32 v170, v90
    v_exp_f32 v171, v91
    v_pk_add_f32 v[164:165], v[164:165], 1.0 op_sel_hi:[1,0]
    v_pk_add_f32 v[166:167], v[166:167], 1.0 op_sel_hi:[1,0]
    v_pk_add_f32 v[168:169], v[168:169], 1.0 op_sel_hi:[1,0]
    v_pk_add_f32 v[170:171], v[170:171], 1.0 op_sel_hi:[1,0]
    v_rcp_f32 v164, v164
    v_rcp_f32 v165, v165
    v_rcp_f32 v166, v166
    v_rcp_f32 v167, v167
    v_rcp_f32 v168, v168
    v_rcp_f32 v169, v169
    v_rcp_f32 v170, v170
    v_rcp_f32 v171, v171
    v_pk_mul_f32 v[84:85], v[84:85], v[164:165]
    v_pk_mul_f32 v[86:87], v[86:87], v[166:167]
    v_pk_mul_f32 v[88:89], v[88:89], v[168:169]
    v_pk_mul_f32 v[90:91], v[90:91], v[170:171]
    v_cvt_pk_bf16_f32 v148, v84, v85
    v_cvt_pk_bf16_f32 v149, v86, v87
    v_cvt_pk_bf16_f32 v150, v88, v89
    v_cvt_pk_bf16_f32 v151, v90, v91
    s_nop 0
    v_permlane32_swap_b32 v148, v150
    v_permlane32_swap_b32 v149, v151
    buffer_store_dwordx4 v[148:151], v161, s[52:55], s80 offen offset:2048 sc1
    v_pk_fma_f32 v[92:93], v[124:125], v[142:143], v[92:93] op_sel_hi:[1,0,1] neg_lo:[0,1,0] neg_hi:[0,1,0]
    v_pk_fma_f32 v[94:95], v[126:127], v[142:143], v[94:95] op_sel_hi:[1,0,1] neg_lo:[0,1,0] neg_hi:[0,1,0]
    v_pk_fma_f32 v[96:97], v[128:129], v[142:143], v[96:97] op_sel_hi:[1,0,1] neg_lo:[0,1,0] neg_hi:[0,1,0]
    v_pk_fma_f32 v[98:99], v[130:131], v[142:143], v[98:99] op_sel_hi:[1,0,1] neg_lo:[0,1,0] neg_hi:[0,1,0]
    v_pk_mul_f32 v[92:93], v[92:93], v[142:143] op_sel:[0,1] op_sel_hi:[1,1]
    v_pk_mul_f32 v[94:95], v[94:95], v[142:143] op_sel:[0,1] op_sel_hi:[1,1]
    v_pk_mul_f32 v[96:97], v[96:97], v[142:143] op_sel:[0,1] op_sel_hi:[1,1]
    v_pk_mul_f32 v[98:99], v[98:99], v[142:143] op_sel:[0,1] op_sel_hi:[1,1]
    v_exp_f32 v164, v92
    v_exp_f32 v165, v93
    v_exp_f32 v166, v94
    v_exp_f32 v167, v95
    v_exp_f32 v168, v96
    v_exp_f32 v169, v97
    v_exp_f32 v170, v98
    v_exp_f32 v171, v99
    v_pk_add_f32 v[164:165], v[164:165], 1.0 op_sel_hi:[1,0]
    v_pk_add_f32 v[166:167], v[166:167], 1.0 op_sel_hi:[1,0]
    v_pk_add_f32 v[168:169], v[168:169], 1.0 op_sel_hi:[1,0]
    v_pk_add_f32 v[170:171], v[170:171], 1.0 op_sel_hi:[1,0]
    v_rcp_f32 v164, v164
    v_rcp_f32 v165, v165
    v_rcp_f32 v166, v166
    v_rcp_f32 v167, v167
    v_rcp_f32 v168, v168
    v_rcp_f32 v169, v169
    v_rcp_f32 v170, v170
    v_rcp_f32 v171, v171
    v_pk_mul_f32 v[92:93], v[92:93], v[164:165]
    v_pk_mul_f32 v[94:95], v[94:95], v[166:167]
    v_pk_mul_f32 v[96:97], v[96:97], v[168:169]
    v_pk_mul_f32 v[98:99], v[98:99], v[170:171]
    v_cvt_pk_bf16_f32 v152, v92, v93
    v_cvt_pk_bf16_f32 v153, v94, v95
    v_cvt_pk_bf16_f32 v154, v96, v97
    v_cvt_pk_bf16_f32 v155, v98, v99
    s_nop 0
    v_permlane32_swap_b32 v152, v154
    v_permlane32_swap_b32 v153, v155
    buffer_store_dwordx4 v[152:155], v161, s[52:55], s80 offen offset:512 sc1
    v_pk_fma_f32 v[100:101], v[132:133], v[142:143], v[100:101] op_sel_hi:[1,0,1] neg_lo:[0,1,0] neg_hi:[0,1,0]
    v_pk_fma_f32 v[102:103], v[134:135], v[142:143], v[102:103] op_sel_hi:[1,0,1] neg_lo:[0,1,0] neg_hi:[0,1,0]
    v_pk_fma_f32 v[104:105], v[136:137], v[142:143], v[104:105] op_sel_hi:[1,0,1] neg_lo:[0,1,0] neg_hi:[0,1,0]
    v_pk_fma_f32 v[106:107], v[138:139], v[142:143], v[106:107] op_sel_hi:[1,0,1] neg_lo:[0,1,0] neg_hi:[0,1,0]
    v_pk_mul_f32 v[100:101], v[100:101], v[142:143] op_sel:[0,1] op_sel_hi:[1,1]
    v_pk_mul_f32 v[102:103], v[102:103], v[142:143] op_sel:[0,1] op_sel_hi:[1,1]
    v_pk_mul_f32 v[104:105], v[104:105], v[142:143] op_sel:[0,1] op_sel_hi:[1,1]
    v_pk_mul_f32 v[106:107], v[106:107], v[142:143] op_sel:[0,1] op_sel_hi:[1,1]
    v_exp_f32 v164, v100
    v_exp_f32 v165, v101
    v_exp_f32 v166, v102
    v_exp_f32 v167, v103
    v_exp_f32 v168, v104
    v_exp_f32 v169, v105
    v_exp_f32 v170, v106
    v_exp_f32 v171, v107
    v_pk_add_f32 v[164:165], v[164:165], 1.0 op_sel_hi:[1,0]
    v_pk_add_f32 v[166:167], v[166:167], 1.0 op_sel_hi:[1,0]
    v_pk_add_f32 v[168:169], v[168:169], 1.0 op_sel_hi:[1,0]
    v_pk_add_f32 v[170:171], v[170:171], 1.0 op_sel_hi:[1,0]
    v_rcp_f32 v164, v164
    v_rcp_f32 v165, v165
    v_rcp_f32 v166, v166
    v_rcp_f32 v167, v167
    v_rcp_f32 v168, v168
    v_rcp_f32 v169, v169
    v_rcp_f32 v170, v170
    v_rcp_f32 v171, v171
    v_pk_mul_f32 v[100:101], v[100:101], v[164:165]
    v_pk_mul_f32 v[102:103], v[102:103], v[166:167]
    v_pk_mul_f32 v[104:105], v[104:105], v[168:169]
    v_pk_mul_f32 v[106:107], v[106:107], v[170:171]
    v_cvt_pk_bf16_f32 v156, v100, v101
    v_cvt_pk_bf16_f32 v157, v102, v103
    v_cvt_pk_bf16_f32 v158, v104, v105
    v_cvt_pk_bf16_f32 v159, v106, v107
    s_nop 0
    v_permlane32_swap_b32 v156, v158
    v_permlane32_swap_b32 v157, v159
    buffer_store_dwordx4 v[156:159], v161, s[52:55], s80 offen offset:2560 sc1
    s_waitcnt vmcnt(0)
    s_lshl_b32 s68, s60, 7
    s_lshl_b32 s69, s61, 2
    s_add_u32 s68, s68, s69
    s_add_u32 s68, s68, 11665408
    v_mov_b32 v164, s67
    v_mov_b32 v165, 0
    s_mov_b64 s[82:83], exec
    s_mov_b64 exec, 1
    buffer_store_dword v164, v165, s[52:55], s68 offen sc1
    s_mov_b64 exec, s[82:83]
    s_setprio 0
    s_branch L_join1
L_LN:
    v_lshrrev_b32 v10, 2, v1
    v_mul_u32_u24 v12, 1056, v10
    v_bfe_u32 v11, v10, 3, 1
    v_lshl_add_u32 v12, v11, 7, v12
    v_and_b32 v11, 3, v1
    v_lshl_add_u32 v12, v11, 4, v12
    s_mul_i32 s69, s61, 17024
    v_add_u32 v12, s69, v12
    s_waitcnt vmcnt(1)
    ds_read_b128 v[16:19], v12 offset:0
    ds_read_b128 v[20:23], v12 offset:64
    ds_read_b128 v[24:27], v12 offset:128
    ds_read_b128 v[28:31], v12 offset:192
    ds_read_b128 v[32:35], v12 offset:256
    ds_read_b128 v[36:39], v12 offset:320
    ds_read_b128 v[40:43], v12 offset:384
    ds_read_b128 v[44:47], v12 offset:448
    ds_read_b128 v[48:51], v12 offset:512
    ds_read_b128 v[52:55], v12 offset:576
    ds_read_b128 v[56:59], v12 offset:640
    ds_read_b128 v[60:63], v12 offset:704
    ds_read_b128 v[64:67], v12 offset:768
    ds_read_b128 v[68:71], v12 offset:832
    ds_read_b128 v[72:75], v12 offset:896
    ds_read_b128 v[76:79], v12 offset:960
    v_mov_b32 v4, 0
    v_mov_b32 v5, 0
    v_mov_b32 v6, 0
    v_mov_b32 v7, 0
    v_mov_b32 v8, 0
    v_mov_b32 v9, 0
    v_mov_b32 v10, 0
    v_mov_b32 v11, 0
    s_mov_b32 s70, 0x3f803f80
    s_waitcnt lgkmcnt(12)
    v_dot2c_f32_bf16 v4, s70, v16
    v_dot2c_f32_bf16 v5, s70, v17
    v_dot2c_f32_bf16 v6, s70, v18
    v_dot2c_f32_bf16 v7, s70, v19
    v_dot2c_f32_bf16 v8, v16, v16
    v_dot2c_f32_bf16 v9, v17, v17
    v_dot2c_f32_bf16 v10, v18, v18
    v_dot2c_f32_bf16 v11, v19, v19
    v_dot2c_f32_bf16 v4, s70, v20
    v_dot2c_f32_bf16 v5, s70, v21
    v_dot2c_f32_bf16 v6, s70, v22
    v_dot2c_f32_bf16 v7, s70, v23
    v_dot2c_f32_bf16 v8, v20, v20
    v_dot2c_f32_bf16 v9, v21, v21
    v_dot2c_f32_bf16 v10, v22, v22
    v_dot2c_f32_bf16 v11, v23, v23
    v_dot2c_f32_bf16 v4, s70, v24
    v_dot2c_f32_bf16 v5, s70, v25
    v_dot2c_f32_bf16 v6, s70, v26
    v_dot2c_f32_bf16 v7, s70, v27
    v_dot2c_f32_bf16 v8, v24, v24
    v_dot2c_f32_bf16 v9, v25, v25
    v_dot2c_f32_bf16 v10, v26, v26
    v_dot2c_f32_bf16 v11, v27, v27
    v_dot2c_f32_bf16 v4, s70, v28
    v_dot2c_f32_bf16 v5, s70, v29
    v_dot2c_f32_bf16 v6, s70, v30
    v_dot2c_f32_bf16 v7, s70, v31
    v_dot2c_f32_bf16 v8, v28, v28
    v_dot2c_f32_bf16 v9, v29, v29
    v_dot2c_f32_bf16 v10, v30, v30
    v_dot2c_f32_bf16 v11, v31, v31
    s_waitcnt lgkmcnt(8)
    v_dot2c_f32_bf16 v4, s70, v32
    v_dot2c_f32_bf16 v5, s70, v33
    v_dot2c_f32_bf16 v6, s70, v34
    v_dot2c_f32_bf16 v7, s70, v35
    v_dot2c_f32_bf16 v8, v32, v32
    v_dot2c_f32_bf16 v9, v33, v33
    v_dot2c_f32_bf16 v10, v34, v34
    v_dot2c_f32_bf16 v11, v35, v35
    v_dot2c_f32_bf16 v4, s70, v36
    v_dot2c_f32_bf16 v5, s70, v37
    v_dot2c_f32_bf16 v6, s70, v38
    v_dot2c_f32_bf16 v7, s70, v39
    v_dot2c_f32_bf16 v8, v36, v36
    v_dot2c_f32_bf16 v9, v37, v37
    v_dot2c_f32_bf16 v10, v38, v38
    v_dot2c_f32_bf16 v11, v39, v39
    v_dot2c_f32_bf16 v4, s70, v40
    v_dot2c_f32_bf16 v5, s70, v41
    v_dot2c_f32_bf16 v6, s70, v42
    v_dot2c_f32_bf16 v7, s70, v43
    v_dot2c_f32_bf16 v8, v40, v40
    v_dot2c_f32_bf16 v9, v41, v41
    v_dot2c_f32_bf16 v10, v42, v42
    v_dot2c_f32_bf16 v11, v43, v43
    v_dot2c_f32_bf16 v4, s70, v44
    v_dot2c_f32_bf16 v5, s70, v45
    v_dot2c_f32_bf16 v6, s70, v46
    v_dot2c_f32_bf16 v7, s70, v47
    v_dot2c_f32_bf16 v8, v44, v44
    v_dot2c_f32_bf16 v9, v45, v45
    v_dot2c_f32_bf16 v10, v46, v46
    v_dot2c_f32_bf16 v11, v47, v47
    s_waitcnt lgkmcnt(4)
    v_dot2c_f32_bf16 v4, s70, v48
    v_dot2c_f32_bf16 v5, s70, v49
    v_dot2c_f32_bf16 v6, s70, v50
    v_dot2c_f32_bf16 v7, s70, v51
    v_dot2c_f32_bf16 v8, v48, v48
    v_dot2c_f32_bf16 v9, v49, v49
    v_dot2c_f32_bf16 v10, v50, v50
    v_dot2c_f32_bf16 v11, v51, v51
    v_dot2c_f32_bf16 v4, s70, v52
    v_dot2c_f32_bf16 v5, s70, v53
    v_dot2c_f32_bf16 v6, s70, v54
    v_dot2c_f32_bf16 v7, s70, v55
    v_dot2c_f32_bf16 v8, v52, v52
    v_dot2c_f32_bf16 v9, v53, v53
    v_dot2c_f32_bf16 v10, v54, v54
    v_dot2c_f32_bf16 v11, v55, v55
    v_dot2c_f32_bf16 v4, s70, v56
    v_dot2c_f32_bf16 v5, s70, v57
    v_dot2c_f32_bf16 v6, s70, v58
    v_dot2c_f32_bf16 v7, s70, v59
    v_dot2c_f32_bf16 v8, v56, v56
    v_dot2c_f32_bf16 v9, v57, v57
    v_dot2c_f32_bf16 v10, v58, v58
    v_dot2c_f32_bf16 v11, v59, v59
    v_dot2c_f32_bf16 v4, s70, v60
    v_dot2c_f32_bf16 v5, s70, v61
    v_dot2c_f32_bf16 v6, s70, v62
    v_dot2c_f32_bf16 v7, s70, v63
    v_dot2c_f32_bf16 v8, v60, v60
    v_dot2c_f32_bf16 v9, v61, v61
    v_dot2c_f32_bf16 v10, v62, v62
    v_dot2c_f32_bf16 v11, v63, v63
    s_waitcnt lgkmcnt(0)
    v_dot2c_f32_bf16 v4, s70, v64
    v_dot2c_f32_bf16 v5, s70, v65
    v_dot2c_f32_bf16 v6, s70, v66
    v_dot2c_f32_bf16 v7, s70, v67
    v_dot2c_f32_bf16 v8, v64, v64
    v_dot2c_f32_bf16 v9, v65, v65
    v_dot2c_f32_bf16 v10, v66, v66
    v_dot2c_f32_bf16 v11, v67, v67
    v_dot2c_f32_bf16 v4, s70, v68
    v_dot2c_f32_bf16 v5, s70, v69
    v_dot2c_f32_bf16 v6, s70, v70
    v_dot2c_f32_bf16 v7, s70, v71
    v_dot2c_f32_bf16 v8, v68, v68
    v_dot2c_f32_bf16 v9, v69, v69
    v_dot2c_f32_bf16 v10, v70, v70
    v_dot2c_f32_bf16 v11, v71, v71
    v_dot2c_f32_bf16 v4, s70, v72
    v_dot2c_f32_bf16 v5, s70, v73
    v_dot2c_f32_bf16 v6, s70, v74
    v_dot2c_f32_bf16 v7, s70, v75
    v_dot2c_f32_bf16 v8, v72, v72
    v_dot2c_f32_bf16 v9, v73, v73
    v_dot2c_f32_bf16 v10, v74, v74
    v_dot2c_f32_bf16 v11, v75, v75
    v_dot2c_f32_bf16 v4, s70, v76
    v_dot2c_f32_bf16 v5, s70, v77
    v_dot2c_f32_bf16 v6, s70, v78
    v_dot2c_f32_bf16 v7, s70, v79
    v_dot2c_f32_bf16 v8, v76, v76
    v_dot2c_f32_bf16 v9, v77, v77
    v_dot2c_f32_bf16 v10, v78, v78
    v_dot2c_f32_bf16 v11, v79, v79
    v_add_f32 v4, v4, v5
    v_add_f32 v6, v6, v7
    v_add_f32 v8, v8, v9
    v_add_f32 v10, v10, v11
    v_add_f32 v4, v4, v6
    v_add_f32 v8, v8, v10
    s_nop 0
    v_add_f32_dpp v4, v4, v4 quad_perm:[1,0,3,2] row_mask:0xf bank_mask:0xf
    v_add_f32_dpp v8, v8, v8 quad_perm:[1,0,3,2] row_mask:0xf bank_mask:0xf
    s_nop 0
    v_add_f32_dpp v4, v4, v4 quad_perm:[2,3,0,1] row_mask:0xf bank_mask:0xf
    v_add_f32_dpp v8, v8, v8 quad_perm:[2,3,0,1] row_mask:0xf bank_mask:0xf
    v_mul_f32 v4, 0x3b000000, v4
    v_mul_f32 v8, 0x3b000000, v8
    v_fma_f32 v8, -v4, v4, v8
    v_max_f32 v8, 0, v8
    v_cvt_pk_bf16_f32 v4, v4, v4
    v_lshlrev_b32 v4, 16, v4
    v_cvt_pk_bf16_f32 v8, v8, v8
    v_lshlrev_b32 v8, 16, v8
    v_add_f32 v8, 0x3727c5ac, v8
    v_cvt_pk_bf16_f32 v8, v8, v8
    v_lshlrev_b32 v8, 16, v8
    v_sqrt_f32 v8, v8
    s_nop 0
    v_cvt_pk_bf16_f32 v8, v8, v8
    v_lshlrev_b32 v8, 16, v8
    v_rcp_f32 v5, v8
    s_nop 0
    v_mul_f32 v6, v4, v5
    v_lshrrev_b32 v10, 2, v1
    v_lshlrev_b32 v11, 3, v10
    s_lshl_b32 s68, s64, 9
    s_lshl_b32 s69, s61, 7
    s_add_u32 s68, s68, s69
    s_add_u32 s68, s68, 11534336
    v_lshlrev_b32 v12, 2, v10
    s_lshl_b32 s69, s61, 6
    s_add_u32 s69, s69, 69632
    v_add_u32 v12, s69, v12
    v_and_b32 v13, 3, v1
    v_cmp_eq_u32 vcc, 0, v13
    s_nop 0
    s_and_saveexec_b64 s[82:83], vcc
    buffer_store_dwordx2 v[4:5], v11, s[52:55], s68 offen sc1
    ds_write_b32 v12, v6 offset:0
    ds_write_b32 v12, v5 offset:256
    s_mov_b64 exec, s[82:83]
    s_waitcnt lgkmcnt(0)
    s_barrier
    v_lshrrev_b32 v10, 4, v1
    v_bfe_u32 v11, v1, 2, 2
    v_lshl_add_u32 v11, v10, 3, v11
    v_mul_u32_u24 v11, 1056, v11
    v_and_b32 v15, 1, v10
    v_lshl_add_u32 v11, v15, 7, v11
    v_lshrrev_b32 v15, 1, v10
    v_lshl_add_u32 v11, v15, 7, v11
    v_and_b32 v15, 3, v1
    v_lshl_add_u32 v11, v15, 3, v11
    s_lshl_b32 s68, s61, 8
    v_add_u32 v12, s68, v11
    v_and_b32 v11, 15, v1
    v_mul_u32_u24 v11, 144, v11
    v_lshrrev_b32 v15, 4, v1
    v_sub_u32 v15, 3, v15
    v_lshl_add_u32 v11, v15, 4, v11
    s_mul_i32 s68, s61, 4608
    s_add_u32 s68, s68, 71680
    v_add_u32 v13, s68, v11
    v_lshrrev_b32 v11, 3, v1
    v_mul_u32_u24 v15, 144, v11
    v_and_b32 v32, 7, v1
    v_lshl_add_u32 v15, v32, 4, v15
    v_add_u32 v33, s68, v15
    v_lshlrev_b32 v32, 4, v32
    v_lshl_add_u32 v14, v11, 12, v32
    v_lshlrev_b32 v10, 5, v10
    v_add_u32 v10, 69632, v10
    ds_read_b128 v[16:19], v10 offset:0
    ds_read_b128 v[20:23], v10 offset:16
    ds_read_b128 v[24:27], v10 offset:256
    ds_read_b128 v[28:31], v10 offset:272
    ds_read_b128 v[88:91], v10 offset:128
    ds_read_b128 v[92:95], v10 offset:144
    ds_read_b128 v[96:99], v10 offset:384
    ds_read_b128 v[100:103], v10 offset:400
    s_waitcnt vmcnt(0)
    v_readfirstlane_b32 s67, v150
    s_nop 0
    s_cmp_lg_u32 s67, 0
    s_cbranch_scc1 L_lnn_32
    s_mov_b32 s100, 0
    v_mov_b32 v151, 0
L_pn_33:
    global_load_dword v150, v151, s[34:35] sc1
    s_waitcnt vmcnt(0)
    v_readfirstlane_b32 s67, v150
    s_add_u32 s100, s100, 1
    s_cmp_lg_u32 s67, 0
    s_cbranch_scc1 L_pnx_34
    s_cmp_lt_u32 s100, 30000
    s_cbranch_scc1 L_pn_33
L_pnx_34:
L_lnn_32:
    s_lshl_b32 s68, s64, 7
    s_lshl_b32 s69, s61, 2
    s_add_u32 s68, s68, s69
    s_add_u32 s68, s68, 11567104
    v_mov_b32 v150, s67
    v_mov_b32 v151, 0
    s_mov_b64 s[82:83], exec
    s_mov_b64 exec, 1
    buffer_store_dword v150, v151, s[52:55], s68 offen sc1
    s_mov_b64 exec, s[82:83]
    s_lshl_b32 s68, s61, 19
    s_lshl_b32 s69, s64, 7
    s_sub_u32 s68, s68, s69
    s_add_u32 s68, s68, 7344000
    ds_read_b64_tr_b16 v[40:41], v12 offset:0
    ds_read_b64_tr_b16 v[42:43], v12 offset:4224
    ds_read_b64_tr_b16 v[48:49], v12 offset:34048
    ds_read_b64_tr_b16 v[50:51], v12 offset:38272
    s_waitcnt lgkmcnt(2)
    v_lshlrev_b32 v56, 16, v40
    v_and_b32 v57, 0xffff0000, v40
    v_lshlrev_b32 v58, 16, v41
    v_and_b32 v59, 0xffff0000, v41
    v_lshlrev_b32 v60, 16, v42
    v_and_b32 v61, 0xffff0000, v42
    v_lshlrev_b32 v62, 16, v43
    v_and_b32 v63, 0xffff0000, v43
    v_pk_fma_f32 v[56:57], v[56:57], v[24:25], v[16:17] neg_lo:[0,0,1] neg_hi:[0,0,1]
    v_pk_fma_f32 v[58:59], v[58:59], v[26:27], v[18:19] neg_lo:[0,0,1] neg_hi:[0,0,1]
    v_pk_fma_f32 v[60:61], v[60:61], v[28:29], v[20:21] neg_lo:[0,0,1] neg_hi:[0,0,1]
    v_pk_fma_f32 v[62:63], v[62:63], v[30:31], v[22:23] neg_lo:[0,0,1] neg_hi:[0,0,1]
    v_cvt_pk_bf16_f32 v44, v63, v62
    v_cvt_pk_bf16_f32 v45, v61, v60
    v_cvt_pk_bf16_f32 v46, v59, v58
    v_cvt_pk_bf16_f32 v47, v57, v56
    ds_write_b128 v13, v[44:47] offset:64
    ds_read_b64_tr_b16 v[40:41], v12 offset:32
    ds_read_b64_tr_b16 v[42:43], v12 offset:4256
    s_waitcnt lgkmcnt(2)
    v_lshlrev_b32 v64, 16, v48
    v_and_b32 v65, 0xffff0000, v48
    v_lshlrev_b32 v66, 16, v49
    v_and_b32 v67, 0xffff0000, v49
    v_lshlrev_b32 v68, 16, v50
    v_and_b32 v69, 0xffff0000, v50
    v_lshlrev_b32 v70, 16, v51
    v_and_b32 v71, 0xffff0000, v51
    v_pk_fma_f32 v[64:65], v[64:65], v[96:97], v[88:89] neg_lo:[0,0,1] neg_hi:[0,0,1]
    v_pk_fma_f32 v[66:67], v[66:67], v[98:99], v[90:91] neg_lo:[0,0,1] neg_hi:[0,0,1]
    v_pk_fma_f32 v[68:69], v[68:69], v[100:101], v[92:93] neg_lo:[0,0,1] neg_hi:[0,0,1]
    v_pk_fma_f32 v[70:71], v[70:71], v[102:103], v[94:95] neg_lo:[0,0,1] neg_hi:[0,0,1]
    v_cvt_pk_bf16_f32 v52, v71, v70
    v_cvt_pk_bf16_f32 v53, v69, v68
    v_cvt_pk_bf16_f32 v54, v67, v66
    v_cvt_pk_bf16_f32 v55, v65, v64
    ds_write_b128 v13, v[52:55] offset:0
    ds_read_b128 v[72:75], v33 offset:0
    ds_read_b128 v[76:79], v33 offset:1152
    ds_read_b64_tr_b16 v[48:49], v12 offset:34080
    ds_read_b64_tr_b16 v[50:51], v12 offset:38304
    s_waitcnt lgkmcnt(2)
    buffer_store_dwordx4 v[72:75], v14, s[52:55], s68 offen sc1
    s_add_u32 s68, s68, 32768
    buffer_store_dwordx4 v[76:79], v14, s[52:55], s68 offen sc1
    s_add_u32 s68, s68, 32768
    v_lshlrev_b32 v56, 16, v40
    v_and_b32 v57, 0xffff0000, v40
    v_lshlrev_b32 v58, 16, v41
    v_and_b32 v59, 0xffff0000, v41
    v_lshlrev_b32 v60, 16, v42
    v_and_b32 v61, 0xffff0000, v42
    v_lshlrev_b32 v62, 16, v43
    v_and_b32 v63, 0xffff0000, v43
    v_pk_fma_f32 v[56:57], v[56:57], v[24:25], v[16:17] neg_lo:[0,0,1] neg_hi:[0,0,1]
    v_pk_fma_f32 v[58:59], v[58:59], v[26:27], v[18:19] neg_lo:[0,0,1] neg_hi:[0,0,1]
    v_pk_fma_f32 v[60:61], v[60:61], v[28:29], v[20:21] neg_lo:[0,0,1] neg_hi:[0,0,1]
    v_pk_fma_f32 v[62:63], v[62:63], v[30:31], v[22:23] neg_lo:[0,0,1] neg_hi:[0,0,1]
    v_cvt_pk_bf16_f32 v44, v63, v62
    v_cvt_pk_bf16_f32 v45, v61, v60
    v_cvt_pk_bf16_f32 v46, v59, v58
    v_cvt_pk_bf16_f32 v47, v57, v56
    ds_write_b128 v13, v[44:47] offset:2368
    ds_read_b64_tr_b16 v[40:41], v12 offset:64
    ds_read_b64_tr_b16 v[42:43], v12 offset:4288
    s_waitcnt lgkmcnt(2)
    v_lshlrev_b32 v64, 16, v48
    v_and_b32 v65, 0xffff0000, v48
    v_lshlrev_b32 v66, 16, v49
    v_and_b32 v67, 0xffff0000, v49
    v_lshlrev_b32 v68, 16, v50
    v_and_b32 v69, 0xffff0000, v50
    v_lshlrev_b32 v70, 16, v51
    v_and_b32 v71, 0xffff0000, v51
    v_pk_fma_f32 v[64:65], v[64:65], v[96:97], v[88:89] neg_lo:[0,0,1] neg_hi:[0,0,1]
    v_pk_fma_f32 v[66:67], v[66:67], v[98:99], v[90:91] neg_lo:[0,0,1] neg_hi:[0,0,1]
    v_pk_fma_f32 v[68:69], v[68:69], v[100:101], v[92:93] neg_lo:[0,0,1] neg_hi:[0,0,1]
    v_pk_fma_f32 v[70:71], v[70:71], v[102:103], v[94:95] neg_lo:[0,0,1] neg_hi:[0,0,1]
    v_cvt_pk_bf16_f32 v52, v71, v70
    v_cvt_pk_bf16_f32 v53, v69, v68
    v_cvt_pk_bf16_f32 v54, v67, v66
    v_cvt_pk_bf16_f32 v55, v65, v64
    ds_write_b128 v13, v[52:55] offset:2304
    ds_read_b128 v[80:83], v33 offset:2304
    ds_read_b128 v[84:87], v33 offset:3456
    ds_read_b64_tr_b16 v[48:49], v12 offset:34112
    ds_read_b64_tr_b16 v[50:51], v12 offset:38336
    s_waitcnt lgkmcnt(2)
    buffer_store_dwordx4 v[80:83], v14, s[52:55], s68 offen sc1
    s_add_u32 s68, s68, 32768
    buffer_store_dwordx4 v[84:87], v14, s[52:55], s68 offen sc1
    s_add_u32 s68, s68, 32768
    v_lshlrev_b32 v56, 16, v40
    v_and_b32 v57, 0xffff0000, v40
    v_lshlrev_b32 v58, 16, v41
    v_and_b32 v59, 0xffff0000, v41
    v_lshlrev_b32 v60, 16, v42
    v_and_b32 v61, 0xffff0000, v42
    v_lshlrev_b32 v62, 16, v43
    v_and_b32 v63, 0xffff0000, v43
    v_pk_fma_f32 v[56:57], v[56:57], v[24:25], v[16:17] neg_lo:[0,0,1] neg_hi:[0,0,1]
    v_pk_fma_f32 v[58:59], v[58:59], v[26:27], v[18:19] neg_lo:[0,0,1] neg_hi:[0,0,1]
    v_pk_fma_f32 v[60:61], v[60:61], v[28:29], v[20:21] neg_lo:[0,0,1] neg_hi:[0,0,1]
    v_pk_fma_f32 v[62:63], v[62:63], v[30:31], v[22:23] neg_lo:[0,0,1] neg_hi:[0,0,1]
    v_cvt_pk_bf16_f32 v44, v63, v62
    v_cvt_pk_bf16_f32 v45, v61, v60
    v_cvt_pk_bf16_f32 v46, v59, v58
    v_cvt_pk_bf16_f32 v47, v57, v56
    ds_write_b128 v13, v[44:47] offset:64
    ds_read_b64_tr_b16 v[40:41], v12 offset:96
    ds_read_b64_tr_b16 v[42:43], v12 offset:4320
    s_waitcnt lgkmcnt(2)
    v_lshlrev_b32 v64, 16, v48
    v_and_b32 v65, 0xffff0000, v48
    v_lshlrev_b32 v66, 16, v49
    v_and_b32 v67, 0xffff0000, v49
    v_lshlrev_b32 v68, 16, v50
    v_and_b32 v69, 0xffff0000, v50
    v_lshlrev_b32 v70, 16, v51
    v_and_b32 v71, 0xffff0000, v51
    v_pk_fma_f32 v[64:65], v[64:65], v[96:97], v[88:89] neg_lo:[0,0,1] neg_hi:[0,0,1]
    v_pk_fma_f32 v[66:67], v[66:67], v[98:99], v[90:91] neg_lo:[0,0,1] neg_hi:[0,0,1]
    v_pk_fma_f32 v[68:69], v[68:69], v[100:101], v[92:93] neg_lo:[0,0,1] neg_hi:[0,0,1]
    v_pk_fma_f32 v[70:71], v[70:71], v[102:103], v[94:95] neg_lo:[0,0,1] neg_hi:[0,0,1]
    v_cvt_pk_bf16_f32 v52, v71, v70
    v_cvt_pk_bf16_f32 v53, v69, v68
    v_cvt_pk_bf16_f32 v54, v67, v66
    v_cvt_pk_bf16_f32 v55, v65, v64
    ds_write_b128 v13, v[52:55] offset:0
    ds_read_b128 v[72:75], v33 offset:0
    ds_read_b128 v[76:79], v33 offset:1152
    ds_read_b64_tr_b16 v[48:49], v12 offset:34144
    ds_read_b64_tr_b16 v[50:51], v12 offset:38368
    s_waitcnt lgkmcnt(2)
    buffer_store_dwordx4 v[72:75], v14, s[52:55], s68 offen sc1
    s_add_u32 s68, s68, 32768
    buffer_store_dwordx4 v[76:79], v14, s[52:55], s68 offen sc1
    s_add_u32 s68, s68, 32768
    v_lshlrev_b32 v56, 16, v40
    v_and_b32 v57, 0xffff0000, v40
    v_lshlrev_b32 v58, 16, v41
    v_and_b32 v59, 0xffff0000, v41
    v_lshlrev_b32 v60, 16, v42
    v_and_b32 v61, 0xffff0000, v42
    v_lshlrev_b32 v62, 16, v43
    v_and_b32 v63, 0xffff0000, v43
    v_pk_fma_f32 v[56:57], v[56:57], v[24:25], v[16:17] neg_lo:[0,0,1] neg_hi:[0,0,1]
    v_pk_fma_f32 v[58:59], v[58:59], v[26:27], v[18:19] neg_lo:[0,0,1] neg_hi:[0,0,1]
    v_pk_fma_f32 v[60:61], v[60:61], v[28:29], v[20:21] neg_lo:[0,0,1] neg_hi:[0,0,1]
    v_pk_fma_f32 v[62:63], v[62:63], v[30:31], v[22:23] neg_lo:[0,0,1] neg_hi:[0,0,1]
    v_cvt_pk_bf16_f32 v44, v63, v62
    v_cvt_pk_bf16_f32 v45, v61, v60
    v_cvt_pk_bf16_f32 v46, v59, v58
    v_cvt_pk_bf16_f32 v47, v57, v56
    ds_write_b128 v13, v[44:47] offset:2368
    ds_read_b64_tr_b16 v[40:41], v12 offset:128
    ds_read_b64_tr_b16 v[42:43], v12 offset:4352
    s_waitcnt lgkmcnt(2)
    v_lshlrev_b32 v64, 16, v48
    v_and_b32 v65, 0xffff0000, v48
    v_lshlrev_b32 v66, 16, v49
    v_and_b32 v67, 0xffff0000, v49
    v_lshlrev_b32 v68, 16, v50
    v_and_b32 v69, 0xffff0000, v50
    v_lshlrev_b32 v70, 16, v51
    v_and_b32 v71, 0xffff0000, v51
    v_pk_fma_f32 v[64:65], v[64:65], v[96:97], v[88:89] neg_lo:[0,0,1] neg_hi:[0,0,1]
    v_pk_fma_f32 v[66:67], v[66:67], v[98:99], v[90:91] neg_lo:[0,0,1] neg_hi:[0,0,1]
    v_pk_fma_f32 v[68:69], v[68:69], v[100:101], v[92:93] neg_lo:[0,0,1] neg_hi:[0,0,1]
    v_pk_fma_f32 v[70:71], v[70:71], v[102:103], v[94:95] neg_lo:[0,0,1] neg_hi:[0,0,1]
    v_cvt_pk_bf16_f32 v52, v71, v70
    v_cvt_pk_bf16_f32 v53, v69, v68
    v_cvt_pk_bf16_f32 v54, v67, v66
    v_cvt_pk_bf16_f32 v55, v65, v64
    ds_write_b128 v13, v[52:55] offset:2304
    ds_read_b128 v[80:83], v33 offset:2304
    ds_read_b128 v[84:87], v33 offset:3456
    ds_read_b64_tr_b16 v[48:49], v12 offset:34176
    ds_read_b64_tr_b16 v[50:51], v12 offset:38400
    s_waitcnt lgkmcnt(2)
    buffer_store_dwordx4 v[80:83], v14, s[52:55], s68 offen sc1
    s_add_u32 s68, s68, 32768
    buffer_store_dwordx4 v[84:87], v14, s[52:55], s68 offen sc1
    s_add_u32 s68, s68, 32768
    v_lshlrev_b32 v56, 16, v40
    v_and_b32 v57, 0xffff0000, v40
    v_lshlrev_b32 v58, 16, v41
    v_and_b32 v59, 0xffff0000, v41
    v_lshlrev_b32 v60, 16, v42
    v_and_b32 v61, 0xffff0000, v42
    v_lshlrev_b32 v62, 16, v43
    v_and_b32 v63, 0xffff0000, v43
    v_pk_fma_f32 v[56:57], v[56:57], v[24:25], v[16:17] neg_lo:[0,0,1] neg_hi:[0,0,1]
    v_pk_fma_f32 v[58:59], v[58:59], v[26:27], v[18:19] neg_lo:[0,0,1] neg_hi:[0,0,1]
    v_pk_fma_f32 v[60:61], v[60:61], v[28:29], v[20:21] neg_lo:[0,0,1] neg_hi:[0,0,1]
    v_pk_fma_f32 v[62:63], v[62:63], v[30:31], v[22:23] neg_lo:[0,0,1] neg_hi:[0,0,1]
    v_cvt_pk_bf16_f32 v44, v63, v62
    v_cvt_pk_bf16_f32 v45, v61, v60
    v_cvt_pk_bf16_f32 v46, v59, v58
    v_cvt_pk_bf16_f32 v47, v57, v56
    ds_write_b128 v13, v[44:47] offset:64
    ds_read_b64_tr_b16 v[40:41], v12 offset:160
    ds_read_b64_tr_b16 v[42:43], v12 offset:4384
    s_waitcnt lgkmcnt(2)
    v_lshlrev_b32 v64, 16, v48
    v_and_b32 v65, 0xffff0000, v48
    v_lshlrev_b32 v66, 16, v49
    v_and_b32 v67, 0xffff0000, v49
    v_lshlrev_b32 v68, 16, v50
    v_and_b32 v69, 0xffff0000, v50
    v_lshlrev_b32 v70, 16, v51
    v_and_b32 v71, 0xffff0000, v51
    v_pk_fma_f32 v[64:65], v[64:65], v[96:97], v[88:89] neg_lo:[0,0,1] neg_hi:[0,0,1]
    v_pk_fma_f32 v[66:67], v[66:67], v[98:99], v[90:91] neg_lo:[0,0,1] neg_hi:[0,0,1]
    v_pk_fma_f32 v[68:69], v[68:69], v[100:101], v[92:93] neg_lo:[0,0,1] neg_hi:[0,0,1]
    v_pk_fma_f32 v[70:71], v[70:71], v[102:103], v[94:95] neg_lo:[0,0,1] neg_hi:[0,0,1]
    v_cvt_pk_bf16_f32 v52, v71, v70
    v_cvt_pk_bf16_f32 v53, v69, v68
    v_cvt_pk_bf16_f32 v54, v67, v66
    v_cvt_pk_bf16_f32 v55, v65, v64
    ds_write_b128 v13, v[52:55] offset:0
    ds_read_b128 v[72:75], v33 offset:0
    ds_read_b128 v[76:79], v33 offset:1152
    ds_read_b64_tr_b16 v[48:49], v12 offset:34208
    ds_read_b64_tr_b16 v[50:51], v12 offset:38432
    s_waitcnt lgkmcnt(2)
    buffer_store_dwordx4 v[72:75], v14, s[52:55], s68 offen sc1
    s_add_u32 s68, s68, 32768
    buffer_store_dwordx4 v[76:79], v14, s[52:55], s68 offen sc1
    s_add_u32 s68, s68, 32768
    v_lshlrev_b32 v56, 16, v40
    v_and_b32 v57, 0xffff0000, v40
    v_lshlrev_b32 v58, 16, v41
    v_and_b32 v59, 0xffff0000, v41
    v_lshlrev_b32 v60, 16, v42
    v_and_b32 v61, 0xffff0000, v42
    v_lshlrev_b32 v62, 16, v43
    v_and_b32 v63, 0xffff0000, v43
    v_pk_fma_f32 v[56:57], v[56:57], v[24:25], v[16:17] neg_lo:[0,0,1] neg_hi:[0,0,1]
    v_pk_fma_f32 v[58:59], v[58:59], v[26:27], v[18:19] neg_lo:[0,0,1] neg_hi:[0,0,1]
    v_pk_fma_f32 v[60:61], v[60:61], v[28:29], v[20:21] neg_lo:[0,0,1] neg_hi:[0,0,1]
    v_pk_fma_f32 v[62:63], v[62:63], v[30:31], v[22:23] neg_lo:[0,0,1] neg_hi:[0,0,1]
    v_cvt_pk_bf16_f32 v44, v63, v62
    v_cvt_pk_bf16_f32 v45, v61, v60
    v_cvt_pk_bf16_f32 v46, v59, v58
    v_cvt_pk_bf16_f32 v47, v57, v56
    ds_write_b128 v13, v[44:47] offset:2368
    ds_read_b64_tr_b16 v[40:41], v12 offset:192
    ds_read_b64_tr_b16 v[42:43], v12 offset:4416
    s_waitcnt lgkmcnt(2)
    v_lshlrev_b32 v64, 16, v48
    v_and_b32 v65, 0xffff0000, v48
    v_lshlrev_b32 v66, 16, v49
    v_and_b32 v67, 0xffff0000, v49
    v_lshlrev_b32 v68, 16, v50
    v_and_b32 v69, 0xffff0000, v50
    v_lshlrev_b32 v70, 16, v51
    v_and_b32 v71, 0xffff0000, v51
    v_pk_fma_f32 v[64:65], v[64:65], v[96:97], v[88:89] neg_lo:[0,0,1] neg_hi:[0,0,1]
    v_pk_fma_f32 v[66:67], v[66:67], v[98:99], v[90:91] neg_lo:[0,0,1] neg_hi:[0,0,1]
    v_pk_fma_f32 v[68:69], v[68:69], v[100:101], v[92:93] neg_lo:[0,0,1] neg_hi:[0,0,1]
    v_pk_fma_f32 v[70:71], v[70:71], v[102:103], v[94:95] neg_lo:[0,0,1] neg_hi:[0,0,1]
    v_cvt_pk_bf16_f32 v52, v71, v70
    v_cvt_pk_bf16_f32 v53, v69, v68
    v_cvt_pk_bf16_f32 v54, v67, v66
    v_cvt_pk_bf16_f32 v55, v65, v64
    ds_write_b128 v13, v[52:55] offset:2304
    ds_read_b128 v[80:83], v33 offset:2304
    ds_read_b128 v[84:87], v33 offset:3456
    ds_read_b64_tr_b16 v[48:49], v12 offset:34240
    ds_read_b64_tr_b16 v[50:51], v12 offset:38464
    s_waitcnt lgkmcnt(2)
    buffer_store_dwordx4 v[80:83], v14, s[52:55], s68 offen sc1
    s_add_u32 s68, s68, 32768
    buffer_store_dwordx4 v[84:87], v14, s[52:55], s68 offen sc1
    s_add_u32 s68, s68, 32768
    v_lshlrev_b32 v56, 16, v40
    v_and_b32 v57, 0xffff0000, v40
    v_lshlrev_b32 v58, 16, v41
    v_and_b32 v59, 0xffff0000, v41
    v_lshlrev_b32 v60, 16, v42
    v_and_b32 v61, 0xffff0000, v42
    v_lshlrev_b32 v62, 16, v43
    v_and_b32 v63, 0xffff0000, v43
    v_pk_fma_f32 v[56:57], v[56:57], v[24:25], v[16:17] neg_lo:[0,0,1] neg_hi:[0,0,1]
    v_pk_fma_f32 v[58:59], v[58:59], v[26:27], v[18:19] neg_lo:[0,0,1] neg_hi:[0,0,1]
    v_pk_fma_f32 v[60:61], v[60:61], v[28:29], v[20:21] neg_lo:[0,0,1] neg_hi:[0,0,1]
    v_pk_fma_f32 v[62:63], v[62:63], v[30:31], v[22:23] neg_lo:[0,0,1] neg_hi:[0,0,1]
    v_cvt_pk_bf16_f32 v44, v63, v62
    v_cvt_pk_bf16_f32 v45, v61, v60
    v_cvt_pk_bf16_f32 v46, v59, v58
    v_cvt_pk_bf16_f32 v47, v57, v56
    ds_write_b128 v13, v[44:47] offset:64
    ds_read_b64_tr_b16 v[40:41], v12 offset:224
    ds_read_b64_tr_b16 v[42:43], v12 offset:4448
    s_waitcnt lgkmcnt(2)
    v_lshlrev_b32 v64, 16, v48
    v_and_b32 v65, 0xffff0000, v48
    v_lshlrev_b32 v66, 16, v49
    v_and_b32 v67, 0xffff0000, v49
    v_lshlrev_b32 v68, 16, v50
    v_and_b32 v69, 0xffff0000, v50
    v_lshlrev_b32 v70, 16, v51
    v_and_b32 v71, 0xffff0000, v51
    v_pk_fma_f32 v[64:65], v[64:65], v[96:97], v[88:89] neg_lo:[0,0,1] neg_hi:[0,0,1]
    v_pk_fma_f32 v[66:67], v[66:67], v[98:99], v[90:91] neg_lo:[0,0,1] neg_hi:[0,0,1]
    v_pk_fma_f32 v[68:69], v[68:69], v[100:101], v[92:93] neg_lo:[0,0,1] neg_hi:[0,0,1]
    v_pk_fma_f32 v[70:71], v[70:71], v[102:103], v[94:95] neg_lo:[0,0,1] neg_hi:[0,0,1]
    v_cvt_pk_bf16_f32 v52, v71, v70
    v_cvt_pk_bf16_f32 v53, v69, v68
    v_cvt_pk_bf16_f32 v54, v67, v66
    v_cvt_pk_bf16_f32 v55, v65, v64
    ds_write_b128 v13, v[52:55] offset:0
    ds_read_b128 v[72:75], v33 offset:0
    ds_read_b128 v[76:79], v33 offset:1152
    ds_read_b64_tr_b16 v[48:49], v12 offset:34272
    ds_read_b64_tr_b16 v[50:51], v12 offset:38496
    s_waitcnt lgkmcnt(2)
    buffer_store_dwordx4 v[72:75], v14, s[52:55], s68 offen sc1
    s_add_u32 s68, s68, 32768
    buffer_store_dwordx4 v[76:79], v14, s[52:55], s68 offen sc1
    s_add_u32 s68, s68, 32768
    v_lshlrev_b32 v56, 16, v40
    v_and_b32 v57, 0xffff0000, v40
    v_lshlrev_b32 v58, 16, v41
    v_and_b32 v59, 0xffff0000, v41
    v_lshlrev_b32 v60, 16, v42
    v_and_b32 v61, 0xffff0000, v42
    v_lshlrev_b32 v62, 16, v43
    v_and_b32 v63, 0xffff0000, v43
    v_pk_fma_f32 v[56:57], v[56:57], v[24:25], v[16:17] neg_lo:[0,0,1] neg_hi:[0,0,1]
    v_pk_fma_f32 v[58:59], v[58:59], v[26:27], v[18:19] neg_lo:[0,0,1] neg_hi:[0,0,1]
    v_pk_fma_f32 v[60:61], v[60:61], v[28:29], v[20:21] neg_lo:[0,0,1] neg_hi:[0,0,1]
    v_pk_fma_f32 v[62:63], v[62:63], v[30:31], v[22:23] neg_lo:[0,0,1] neg_hi:[0,0,1]
    v_cvt_pk_bf16_f32 v44, v63, v62
    v_cvt_pk_bf16_f32 v45, v61, v60
    v_cvt_pk_bf16_f32 v46, v59, v58
    v_cvt_pk_bf16_f32 v47, v57, v56
    ds_write_b128 v13, v[44:47] offset:2368
    s_waitcnt lgkmcnt(0)
    v_lshlrev_b32 v64, 16, v48
    v_and_b32 v65, 0xffff0000, v48
    v_lshlrev_b32 v66, 16, v49
    v_and_b32 v67, 0xffff0000, v49
    v_lshlrev_b32 v68, 16, v50
    v_and_b32 v69, 0xffff0000, v50
    v_lshlrev_b32 v70, 16, v51
    v_and_b32 v71, 0xffff0000, v51
    v_pk_fma_f32 v[64:65], v[64:65], v[96:97], v[88:89] neg_lo:[0,0,1] neg_hi:[0,0,1]
    v_pk_fma_f32 v[66:67], v[66:67], v[98:99], v[90:91] neg_lo:[0,0,1] neg_hi:[0,0,1]
    v_pk_fma_f32 v[68:69], v[68:69], v[100:101], v[92:93] neg_lo:[0,0,1] neg_hi:[0,0,1]
    v_pk_fma_f32 v[70:71], v[70:71], v[102:103], v[94:95] neg_lo:[0,0,1] neg_hi:[0,0,1]
    v_cvt_pk_bf16_f32 v52, v71, v70
    v_cvt_pk_bf16_f32 v53, v69, v68
    v_cvt_pk_bf16_f32 v54, v67, v66
    v_cvt_pk_bf16_f32 v55, v65, v64
    ds_write_b128 v13, v[52:55] offset:2304
    ds_read_b128 v[80:83], v33 offset:2304
    ds_read_b128 v[84:87], v33 offset:3456
    s_waitcnt lgkmcnt(0)
    buffer_store_dwordx4 v[80:83], v14, s[52:55], s68 offen sc1
    s_add_u32 s68, s68, 32768
    buffer_store_dwordx4 v[84:87], v14, s[52:55], s68 offen sc1
    s_add_u32 s68, s68, 32768
    s_waitcnt vmcnt(0)
    s_lshl_b32 s68, s64, 7
    s_lshl_b32 s69, s61, 2
    s_add_u32 s68, s68, s69
    s_add_u32 s68, s68, 11632640
    v_mov_b32 v150, s67
    v_mov_b32 v151, 0
    s_mov_b64 s[82:83], exec
    s_mov_b64 exec, 1
    buffer_store_dword v150, v151, s[52:55], s68 offen sc1
    s_mov_b64 exec, s[82:83]
    s_setprio 0
    s_barrier
    s_barrier
    s_branch L_join1
L_HLN:
    s_barrier
    v_and_b32 v2, 255, v0
    v_mov_b32 v4, 0
    v_mov_b32 v5, 0
    v_mov_b32 v6, 0
    v_mov_b32 v7, 0
    s_mov_b64 s[82:83], exec
    s_lshr_b32 s71, s101, 1
    s_mul_i32 s71, s71, 11520
    s_and_b32 s72, s101, 1
    s_mul_i32 s72, s72, 640
    s_add_u32 s71, s71, s72
    s_add_u32 s71, s71, 131584
    v_lshlrev_b32 v3, 3, v1
    v_add_u32 v3, s71, v3
    ds_write_b64 v3, v[4:5]
    s_mov_b64 exec, 0xffff
    ds_write_b64 v3, v[4:5] offset:512
    s_mov_b64 exec, -1
    v_and_b32 v9, 15, v1
    v_lshlrev_b32 v16, 3, v9
    v_cvt_f32_u32 v20, v16
    v_and_b32 v16, 7, v9
    v_lshrrev_b32 v17, 3, v9
    v_lshl_add_u32 v16, v17, 7, v16
    v_cvt_f32_u32 v22, v16
    v_and_b32 v16, 3, v9
    v_lshlrev_b32 v16, 1, v16
    v_bfe_u32 v17, v9, 2, 1
    v_lshl_add_u32 v16, v17, 7, v16
    v_add_u32 v16, 256, v16
    v_and_b32 v17, 1, v9
    v_lshlrev_b32 v17, 2, v17
    v_bfe_u32 v18, v9, 1, 2
    v_lshl_add_u32 v17, v18, 7, v17
    v_add_u32 v17, 512, v17
    v_cmp_gt_u32 vcc, 8, v9
    s_nop 1
    v_cndmask_b32 v16, v17, v16, vcc
    v_cvt_f32_u32 v24, v16
    v_lshlrev_b32 v16, 7, v9
    v_add_u32 v16, 1024, v16
    v_cvt_f32_u32 v26, v16
    v_mov_b32 v111, 0
    global_load_dword v110, v111, s[34:35] sc1
    s_lshr_b32 s68, s101, 1
    s_waitcnt vmcnt(2)
    v_lshlrev_b32 v16, 16, v19
    v_mul_f32 v16, 0x3fb8aa3b, v16
    v_exp_f32 v16, v16
    s_nop 0
    v_cvt_pk_bf16_f32 v16, v16, v16
    v_lshlrev_b32 v16, 16, v16
    v_lshlrev_b32 v10, 16, v10
    v_lshlrev_b32 v11, 16, v11
    v_lshlrev_b32 v12, 16, v12
    v_lshlrev_b32 v13, 16, v13
    v_lshlrev_b32 v14, 16, v14
    v_lshlrev_b32 v15, 16, v15
    v_mul_f32 v104, v16, v10
    v_mul_f32 v104, 0x3fb8aa3b, v104
    v_mul_f32 v105, v16, v11
    v_mul_f32 v105, 0x3e22f983, v105
    v_rndne_f32 v108, v105
    v_sub_f32 v105, v105, v108
    v_mul_f32 v12, v16, v12
    v_mul_f32 v13, v16, v13
    v_mul_f32 v106, v14, v12
    v_fma_f32 v106, -v15, v13, v106
    v_mul_f32 v107, v14, v13
    v_fma_f32 v107, v15, v12, v107
    s_lshl_b32 s69, s101, 10
    s_add_u32 s69, s69, 133632
    v_lshlrev_b32 v3, 4, v1
    v_add_u32 v3, s69, v3
    ds_write_b128 v3, v[104:107]
    v_lshrrev_b32 v3, 4, v1
    v_lshlrev_b32 v3, 8, v3
    v_add_u32 v28, s69, v3
    ds_read_b128 v[48:51], v28
    s_waitcnt lgkmcnt(0)
    ds_read_b128 v[52:55], v28 offset:16
    v_mul_f32 v73, v49, v20
    v_mul_f32 v75, v49, v22
    v_mul_f32 v77, v49, v24
    v_mul_f32 v79, v49, v26
    v_mul_f32 v72, v48, v20
    v_mul_f32 v74, v48, v22
    v_mul_f32 v76, v48, v24
    v_mul_f32 v78, v48, v26
    v_fract_f32 v77, v77
    v_fract_f32 v79, v79
    v_cos_f32 v88, v73
    v_cos_f32 v90, v75
    v_cos_f32 v92, v77
    v_cos_f32 v94, v79
    v_sin_f32 v89, v73
    v_sin_f32 v91, v75
    v_sin_f32 v93, v77
    v_sin_f32 v95, v79
    v_exp_f32 v80, v72
    v_exp_f32 v82, v74
    v_exp_f32 v84, v76
    v_exp_f32 v86, v78
    v_mul_f32 v96, v50, v88
    v_mul_f32 v97, v50, v89
    v_fma_f32 v96, -v51, v89, v96
    v_fma_f32 v97, -v51, v88, -v97
    v_mul_f32 v90, v90, v82
    v_mul_f32 v91, v91, v82
    v_mul_f32 v92, v92, v84
    v_mul_f32 v93, v93, v84
    v_mul_f32 v94, v94, v86
    v_mul_f32 v95, v95, v86
    v_mul_f32 v96, v96, v80
    v_mul_f32 v97, v97, v80
    v_cvt_pk_bf16_f32 v128, v90, v91
    v_cvt_pk_bf16_f32 v132, v92, v93
    v_cvt_pk_bf16_f32 v136, v94, v95
    v_cvt_pk_bf16_f32 v140, v96, v97
    s_waitcnt lgkmcnt(0)
    ds_read_b128 v[48:51], v28 offset:32
    v_mul_f32 v73, v53, v20
    v_mul_f32 v75, v53, v22
    v_mul_f32 v77, v53, v24
    v_mul_f32 v79, v53, v26
    v_mul_f32 v72, v52, v20
    v_mul_f32 v74, v52, v22
    v_mul_f32 v76, v52, v24
    v_mul_f32 v78, v52, v26
    v_fract_f32 v77, v77
    v_fract_f32 v79, v79
    v_cos_f32 v88, v73
    v_cos_f32 v90, v75
    v_cos_f32 v92, v77
    v_cos_f32 v94, v79
    v_sin_f32 v89, v73
    v_sin_f32 v91, v75
    v_sin_f32 v93, v77
    v_sin_f32 v95, v79
    v_exp_f32 v80, v72
    v_exp_f32 v82, v74
    v_exp_f32 v84, v76
    v_exp_f32 v86, v78
    v_mul_f32 v96, v54, v88
    v_mul_f32 v97, v54, v89
    v_fma_f32 v96, -v55, v89, v96
    v_fma_f32 v97, -v55, v88, -v97
    v_mul_f32 v90, v90, v82
    v_mul_f32 v91, v91, v82
    v_mul_f32 v92, v92, v84
    v_mul_f32 v93, v93, v84
    v_mul_f32 v94, v94, v86
    v_mul_f32 v95, v95, v86
    v_mul_f32 v96, v96, v80
    v_mul_f32 v97, v97, v80
    v_cvt_pk_bf16_f32 v129, v90, v91
    v_cvt_pk_bf16_f32 v133, v92, v93
    v_cvt_pk_bf16_f32 v137, v94, v95
    v_cvt_pk_bf16_f32 v141, v96, v97
    s_waitcnt lgkmcnt(0)
    ds_read_b128 v[52:55], v28 offset:48
    v_mul_f32 v73, v49, v20
    v_mul_f32 v75, v49, v22
    v_mul_f32 v77, v49, v24
    v_mul_f32 v79, v49, v26
    v_mul_f32 v72, v48, v20
    v_mul_f32 v74, v48, v22
    v_mul_f32 v76, v48, v24
    v_mul_f32 v78, v48, v26
    v_fract_f32 v77, v77
    v_fract_f32 v79, v79
    v_cos_f32 v88, v73
    v_cos_f32 v90, v75
    v_cos_f32 v92, v77
    v_cos_f32 v94, v79
    v_sin_f32 v89, v73
    v_sin_f32 v91, v75
    v_sin_f32 v93, v77
    v_sin_f32 v95, v79
    v_exp_f32 v80, v72
    v_exp_f32 v82, v74
    v_exp_f32 v84, v76
    v_exp_f32 v86, v78
    v_mul_f32 v96, v50, v88
    v_mul_f32 v97, v50, v89
    v_fma_f32 v96, -v51, v89, v96
    v_fma_f32 v97, -v51, v88, -v97
    v_mul_f32 v90, v90, v82
    v_mul_f32 v91, v91, v82
    v_mul_f32 v92, v92, v84
    v_mul_f32 v93, v93, v84
    v_mul_f32 v94, v94, v86
    v_mul_f32 v95, v95, v86
    s_waitcnt vmcnt(0)
    v_readfirstlane_b32 s67, v110
    s_nop 0
    s_cmp_lg_u32 s67, 0
    s_cbranch_scc1 L_hn_35
    s_mov_b32 s100, 0
    v_mov_b32 v111, 0
L_pn_36:
    global_load_dword v110, v111, s[34:35] sc1
    s_waitcnt vmcnt(0)
    v_readfirstlane_b32 s67, v110
    s_add_u32 s100, s100, 1
    s_cmp_lg_u32 s67, 0
    s_cbranch_scc1 L_pnx_37
    s_cmp_lt_u32 s100, 30000
    s_cbranch_scc1 L_pn_36
L_pnx_37:
L_hn_35:
    v_mov_b32 v110, 160768
    v_mov_b32 v111, s67
    ds_write_b32 v110, v111
    v_mul_f32 v96, v96, v80
    v_mul_f32 v97, v97, v80
    v_cvt_pk_bf16_f32 v130, v90, v91
    v_cvt_pk_bf16_f32 v134, v92, v93
    v_cvt_pk_bf16_f32 v138, v94, v95
    v_cvt_pk_bf16_f32 v142, v96, v97
    s_waitcnt lgkmcnt(0)
    ds_read_b128 v[48:51], v28 offset:64
    v_mul_f32 v73, v53, v20
    v_mul_f32 v75, v53, v22
    v_mul_f32 v77, v53, v24
    v_mul_f32 v79, v53, v26
    v_mul_f32 v72, v52, v20
    v_mul_f32 v74, v52, v22
    v_mul_f32 v76, v52, v24
    v_mul_f32 v78, v52, v26
    v_fract_f32 v77, v77
    v_fract_f32 v79, v79
    v_cos_f32 v88, v73
    v_cos_f32 v90, v75
    v_cos_f32 v92, v77
    v_cos_f32 v94, v79
    v_sin_f32 v89, v73
    v_sin_f32 v91, v75
    v_sin_f32 v93, v77
    v_sin_f32 v95, v79
    v_exp_f32 v80, v72
    v_exp_f32 v82, v74
    v_exp_f32 v84, v76
    v_exp_f32 v86, v78
    v_mul_f32 v96, v54, v88
    v_mul_f32 v97, v54, v89
    v_fma_f32 v96, -v55, v89, v96
    v_fma_f32 v97, -v55, v88, -v97
    v_mul_f32 v90, v90, v82
    v_mul_f32 v91, v91, v82
    v_mul_f32 v92, v92, v84
    v_mul_f32 v93, v93, v84
    v_mul_f32 v94, v94, v86
    v_mul_f32 v95, v95, v86
    v_mul_f32 v96, v96, v80
    v_mul_f32 v97, v97, v80
    v_cvt_pk_bf16_f32 v131, v90, v91
    v_cvt_pk_bf16_f32 v135, v92, v93
    v_cvt_pk_bf16_f32 v139, v94, v95
    v_cvt_pk_bf16_f32 v143, v96, v97
    s_waitcnt lgkmcnt(0)
    ds_read_b128 v[52:55], v28 offset:80
    v_mul_f32 v73, v49, v20
    v_mul_f32 v75, v49, v22
    v_mul_f32 v77, v49, v24
    v_mul_f32 v79, v49, v26
    v_mul_f32 v72, v48, v20
    v_mul_f32 v74, v48, v22
    v_mul_f32 v76, v48, v24
    v_mul_f32 v78, v48, v26
    v_fract_f32 v77, v77
    v_fract_f32 v79, v79
    v_cos_f32 v88, v73
    v_cos_f32 v90, v75
    v_cos_f32 v92, v77
    v_cos_f32 v94, v79
    v_sin_f32 v89, v73
    v_sin_f32 v91, v75
    v_sin_f32 v93, v77
    v_sin_f32 v95, v79
    v_exp_f32 v80, v72
    v_exp_f32 v82, v74
    v_exp_f32 v84, v76
    v_exp_f32 v86, v78
    v_mul_f32 v96, v50, v88
    v_mul_f32 v97, v50, v89
    v_fma_f32 v96, -v51, v89, v96
    v_fma_f32 v97, -v51, v88, -v97
    v_mul_f32 v90, v90, v82
    v_mul_f32 v91, v91, v82
    v_mul_f32 v92, v92, v84
    v_mul_f32 v93, v93, v84
    v_mul_f32 v94, v94, v86
    v_mul_f32 v95, v95, v86
    v_mul_f32 v96, v96, v80
    v_mul_f32 v97, v97, v80
    v_cvt_pk_bf16_f32 v144, v90, v91
    v_cvt_pk_bf16_f32 v148, v92, v93
    v_cvt_pk_bf16_f32 v152, v94, v95
    v_cvt_pk_bf16_f32 v156, v96, v97
    s_waitcnt lgkmcnt(0)
    ds_read_b128 v[48:51], v28 offset:96
    v_mul_f32 v73, v53, v20
    v_mul_f32 v75, v53, v22
    v_mul_f32 v77, v53, v24
    v_mul_f32 v79, v53, v26
    v_mul_f32 v72, v52, v20
    v_mul_f32 v74, v52, v22
    v_mul_f32 v76, v52, v24
    v_mul_f32 v78, v52, v26
    v_fract_f32 v77, v77
    v_fract_f32 v79, v79
    v_cos_f32 v88, v73
    v_cos_f32 v90, v75
    v_cos_f32 v92, v77
    v_cos_f32 v94, v79
    v_sin_f32 v89, v73
    v_sin_f32 v91, v75
    v_sin_f32 v93, v77
    v_sin_f32 v95, v79
    v_exp_f32 v80, v72
    v_exp_f32 v82, v74
    v_exp_f32 v84, v76
    v_exp_f32 v86, v78
    v_mul_f32 v96, v54, v88
    v_mul_f32 v97, v54, v89
    v_fma_f32 v96, -v55, v89, v96
    v_fma_f32 v97, -v55, v88, -v97
    v_mul_f32 v90, v90, v82
    v_mul_f32 v91, v91, v82
    v_mul_f32 v92, v92, v84
    v_mul_f32 v93, v93, v84
    v_mul_f32 v94, v94, v86
    v_mul_f32 v95, v95, v86
    v_mul_f32 v96, v96, v80
    v_mul_f32 v97, v97, v80
    v_cvt_pk_bf16_f32 v145, v90, v91
    v_cvt_pk_bf16_f32 v149, v92, v93
    v_cvt_pk_bf16_f32 v153, v94, v95
    v_cvt_pk_bf16_f32 v157, v96, v97
    s_waitcnt lgkmcnt(0)
    ds_read_b128 v[52:55], v28 offset:112
    v_mul_f32 v73, v49, v20
    v_mul_f32 v75, v49, v22
    v_mul_f32 v77, v49, v24
    v_mul_f32 v79, v49, v26
    v_mul_f32 v72, v48, v20
    v_mul_f32 v74, v48, v22
    v_mul_f32 v76, v48, v24
    v_mul_f32 v78, v48, v26
    v_fract_f32 v77, v77
    v_fract_f32 v79, v79
    v_cos_f32 v88, v73
    v_cos_f32 v90, v75
    v_cos_f32 v92, v77
    v_cos_f32 v94, v79
    v_sin_f32 v89, v73
    v_sin_f32 v91, v75
    v_sin_f32 v93, v77
    v_sin_f32 v95, v79
    v_exp_f32 v80, v72
    v_exp_f32 v82, v74
    v_exp_f32 v84, v76
    v_exp_f32 v86, v78
    v_mul_f32 v96, v50, v88
    v_mul_f32 v97, v50, v89
    v_fma_f32 v96, -v51, v89, v96
    v_fma_f32 v97, -v51, v88, -v97
    v_mul_f32 v90, v90, v82
    v_mul_f32 v91, v91, v82
    v_mul_f32 v92, v92, v84
    v_mul_f32 v93, v93, v84
    v_mul_f32 v94, v94, v86
    v_mul_f32 v95, v95, v86
    v_mul_f32 v96, v96, v80
    v_mul_f32 v97, v97, v80
    v_cvt_pk_bf16_f32 v146, v90, v91
    v_cvt_pk_bf16_f32 v150, v92, v93
    v_cvt_pk_bf16_f32 v154, v94, v95
    v_cvt_pk_bf16_f32 v158, v96, v97
    s_waitcnt lgkmcnt(0)
    ds_read_b128 v[48:51], v28 offset:128
    v_mul_f32 v73, v53, v20
    v_mul_f32 v75, v53, v22
    v_mul_f32 v77, v53, v24
    v_mul_f32 v79, v53, v26
    v_mul_f32 v72, v52, v20
    v_mul_f32 v74, v52, v22
    v_mul_f32 v76, v52, v24
    v_mul_f32 v78, v52, v26
    v_fract_f32 v77, v77
    v_fract_f32 v79, v79
    v_cos_f32 v88, v73
    v_cos_f32 v90, v75
    v_cos_f32 v92, v77
    v_cos_f32 v94, v79
    v_sin_f32 v89, v73
    v_sin_f32 v91, v75
    v_sin_f32 v93, v77
    v_sin_f32 v95, v79
    v_exp_f32 v80, v72
    v_exp_f32 v82, v74
    v_exp_f32 v84, v76
    v_exp_f32 v86, v78
    v_mul_f32 v96, v54, v88
    v_mul_f32 v97, v54, v89
    v_fma_f32 v96, -v55, v89, v96
    v_fma_f32 v97, -v55, v88, -v97
    v_mul_f32 v90, v90, v82
    v_mul_f32 v91, v91, v82
    v_mul_f32 v92, v92, v84
    v_mul_f32 v93, v93, v84
    v_mul_f32 v94, v94, v86
    v_mul_f32 v95, v95, v86
    v_mul_f32 v96, v96, v80
    v_mul_f32 v97, v97, v80
    v_cvt_pk_bf16_f32 v147, v90, v91
    v_cvt_pk_bf16_f32 v151, v92, v93
    v_cvt_pk_bf16_f32 v155, v94, v95
    v_cvt_pk_bf16_f32 v159, v96, v97
    s_waitcnt lgkmcnt(0)
    ds_read_b128 v[52:55], v28 offset:144
    v_mul_f32 v73, v49, v20
    v_mul_f32 v75, v49, v22
    v_mul_f32 v77, v49, v24
    v_mul_f32 v79, v49, v26
    v_mul_f32 v72, v48, v20
    v_mul_f32 v74, v48, v22
    v_mul_f32 v76, v48, v24
    v_mul_f32 v78, v48, v26
    v_fract_f32 v77, v77
    v_fract_f32 v79, v79
    v_cos_f32 v88, v73
    v_cos_f32 v90, v75
    v_cos_f32 v92, v77
    v_cos_f32 v94, v79
    v_sin_f32 v89, v73
    v_sin_f32 v91, v75
    v_sin_f32 v93, v77
    v_sin_f32 v95, v79
    v_exp_f32 v80, v72
    v_exp_f32 v82, v74
    v_exp_f32 v84, v76
    v_exp_f32 v86, v78
    v_mul_f32 v96, v50, v88
    v_mul_f32 v97, v50, v89
    v_fma_f32 v96, -v51, v89, v96
    v_fma_f32 v97, -v51, v88, -v97
    v_mul_f32 v90, v90, v82
    v_mul_f32 v91, v91, v82
    v_mul_f32 v92, v92, v84
    v_mul_f32 v93, v93, v84
    v_mul_f32 v94, v94, v86
    v_mul_f32 v95, v95, v86
    v_mul_f32 v96, v96, v80
    v_mul_f32 v97, v97, v80
    v_cvt_pk_bf16_f32 v160, v90, v91
    v_cvt_pk_bf16_f32 v164, v92, v93
    v_cvt_pk_bf16_f32 v168, v94, v95
    v_cvt_pk_bf16_f32 v172, v96, v97
    s_waitcnt lgkmcnt(0)
    ds_read_b128 v[48:51], v28 offset:160
    v_mul_f32 v73, v53, v20
    v_mul_f32 v75, v53, v22
    v_mul_f32 v77, v53, v24
    v_mul_f32 v79, v53, v26
    v_mul_f32 v72, v52, v20
    v_mul_f32 v74, v52, v22
    v_mul_f32 v76, v52, v24
    v_mul_f32 v78, v52, v26
    v_fract_f32 v77, v77
    v_fract_f32 v79, v79
    v_cos_f32 v88, v73
    v_cos_f32 v90, v75
    v_cos_f32 v92, v77
    v_cos_f32 v94, v79
    v_sin_f32 v89, v73
    v_sin_f32 v91, v75
    v_sin_f32 v93, v77
    v_sin_f32 v95, v79
    v_exp_f32 v80, v72
    v_exp_f32 v82, v74
    v_exp_f32 v84, v76
    v_exp_f32 v86, v78
    v_mul_f32 v96, v54, v88
    v_mul_f32 v97, v54, v89
    v_fma_f32 v96, -v55, v89, v96
    v_fma_f32 v97, -v55, v88, -v97
    v_mul_f32 v90, v90, v82
    v_mul_f32 v91, v91, v82
    v_mul_f32 v92, v92, v84
    v_mul_f32 v93, v93, v84
    v_mul_f32 v94, v94, v86
    v_mul_f32 v95, v95, v86
    v_mul_f32 v96, v96, v80
    v_mul_f32 v97, v97, v80
    v_cvt_pk_bf16_f32 v161, v90, v91
    v_cvt_pk_bf16_f32 v165, v92, v93
    v_cvt_pk_bf16_f32 v169, v94, v95
    v_cvt_pk_bf16_f32 v173, v96, v97
    s_waitcnt lgkmcnt(0)
    ds_read_b128 v[52:55], v28 offset:176
    v_mul_f32 v73, v49, v20
    v_mul_f32 v75, v49, v22
    v_mul_f32 v77, v49, v24
    v_mul_f32 v79, v49, v26
    v_mul_f32 v72, v48, v20
    v_mul_f32 v74, v48, v22
    v_mul_f32 v76, v48, v24
    v_mul_f32 v78, v48, v26
    v_fract_f32 v77, v77
    v_fract_f32 v79, v79
    v_cos_f32 v88, v73
    v_cos_f32 v90, v75
    v_cos_f32 v92, v77
    v_cos_f32 v94, v79
    v_sin_f32 v89, v73
    v_sin_f32 v91, v75
    v_sin_f32 v93, v77
    v_sin_f32 v95, v79
    v_exp_f32 v80, v72
    v_exp_f32 v82, v74
    v_exp_f32 v84, v76
    v_exp_f32 v86, v78
    v_mul_f32 v96, v50, v88
    v_mul_f32 v97, v50, v89
    v_fma_f32 v96, -v51, v89, v96
    v_fma_f32 v97, -v51, v88, -v97
    v_mul_f32 v90, v90, v82
    v_mul_f32 v91, v91, v82
    v_mul_f32 v92, v92, v84
    v_mul_f32 v93, v93, v84
    v_mul_f32 v94, v94, v86
    v_mul_f32 v95, v95, v86
    v_mul_f32 v96, v96, v80
    v_mul_f32 v97, v97, v80
    v_cvt_pk_bf16_f32 v162, v90, v91
    v_cvt_pk_bf16_f32 v166, v92, v93
    v_cvt_pk_bf16_f32 v170, v94, v95
    v_cvt_pk_bf16_f32 v174, v96, v97
    s_waitcnt lgkmcnt(0)
    ds_read_b128 v[48:51], v28 offset:192
    v_mul_f32 v73, v53, v20
    v_mul_f32 v75, v53, v22
    v_mul_f32 v77, v53, v24
    v_mul_f32 v79, v53, v26
    v_mul_f32 v72, v52, v20
    v_mul_f32 v74, v52, v22
    v_mul_f32 v76, v52, v24
    v_mul_f32 v78, v52, v26
    v_fract_f32 v77, v77
    v_fract_f32 v79, v79
    v_cos_f32 v88, v73
    v_cos_f32 v90, v75
    v_cos_f32 v92, v77
    v_cos_f32 v94, v79
    v_sin_f32 v89, v73
    v_sin_f32 v91, v75
    v_sin_f32 v93, v77
    v_sin_f32 v95, v79
    v_exp_f32 v80, v72
    v_exp_f32 v82, v74
    v_exp_f32 v84, v76
    v_exp_f32 v86, v78
    v_mul_f32 v96, v54, v88
    v_mul_f32 v97, v54, v89
    v_fma_f32 v96, -v55, v89, v96
    v_fma_f32 v97, -v55, v88, -v97
    v_mul_f32 v90, v90, v82
    v_mul_f32 v91, v91, v82
    v_mul_f32 v92, v92, v84
    v_mul_f32 v93, v93, v84
    v_mul_f32 v94, v94, v86
    v_mul_f32 v95, v95, v86
    v_mul_f32 v96, v96, v80
    v_mul_f32 v97, v97, v80
    v_cvt_pk_bf16_f32 v163, v90, v91
    v_cvt_pk_bf16_f32 v167, v92, v93
    v_cvt_pk_bf16_f32 v171, v94, v95
    v_cvt_pk_bf16_f32 v175, v96, v97
    s_waitcnt lgkmcnt(0)
    ds_read_b128 v[52:55], v28 offset:208
    v_mul_f32 v73, v49, v20
    v_mul_f32 v75, v49, v22
    v_mul_f32 v77, v49, v24
    v_mul_f32 v79, v49, v26
    v_mul_f32 v72, v48, v20
    v_mul_f32 v74, v48, v22
    v_mul_f32 v76, v48, v24
    v_mul_f32 v78, v48, v26
    v_fract_f32 v77, v77
    v_fract_f32 v79, v79
    v_cos_f32 v88, v73
    v_cos_f32 v90, v75
    v_cos_f32 v92, v77
    v_cos_f32 v94, v79
    v_sin_f32 v89, v73
    v_sin_f32 v91, v75
    v_sin_f32 v93, v77
    v_sin_f32 v95, v79
    v_exp_f32 v80, v72
    v_exp_f32 v82, v74
    v_exp_f32 v84, v76
    v_exp_f32 v86, v78
    v_mul_f32 v96, v50, v88
    v_mul_f32 v97, v50, v89
    v_fma_f32 v96, -v51, v89, v96
    v_fma_f32 v97, -v51, v88, -v97
    v_mul_f32 v90, v90, v82
    v_mul_f32 v91, v91, v82
    v_mul_f32 v92, v92, v84
    v_mul_f32 v93, v93, v84
    v_mul_f32 v94, v94, v86
    v_mul_f32 v95, v95, v86
    v_mul_f32 v96, v96, v80
    v_mul_f32 v97, v97, v80
    v_cvt_pk_bf16_f32 v176, v90, v91
    v_cvt_pk_bf16_f32 v180, v92, v93
    v_cvt_pk_bf16_f32 v184, v94, v95
    v_cvt_pk_bf16_f32 v188, v96, v97
    s_waitcnt lgkmcnt(0)
    ds_read_b128 v[48:51], v28 offset:224
    v_mul_f32 v73, v53, v20
    v_mul_f32 v75, v53, v22
    v_mul_f32 v77, v53, v24
    v_mul_f32 v79, v53, v26
    v_mul_f32 v72, v52, v20
    v_mul_f32 v74, v52, v22
    v_mul_f32 v76, v52, v24
    v_mul_f32 v78, v52, v26
    v_fract_f32 v77, v77
    v_fract_f32 v79, v79
    v_cos_f32 v88, v73
    v_cos_f32 v90, v75
    v_cos_f32 v92, v77
    v_cos_f32 v94, v79
    v_sin_f32 v89, v73
    v_sin_f32 v91, v75
    v_sin_f32 v93, v77
    v_sin_f32 v95, v79
    v_exp_f32 v80, v72
    v_exp_f32 v82, v74
    v_exp_f32 v84, v76
    v_exp_f32 v86, v78
    v_mul_f32 v96, v54, v88
    v_mul_f32 v97, v54, v89
    v_fma_f32 v96, -v55, v89, v96
    v_fma_f32 v97, -v55, v88, -v97
    v_mul_f32 v90, v90, v82
    v_mul_f32 v91, v91, v82
    v_mul_f32 v92, v92, v84
    v_mul_f32 v93, v93, v84
    v_mul_f32 v94, v94, v86
    v_mul_f32 v95, v95, v86
    v_mul_f32 v96, v96, v80
    v_mul_f32 v97, v97, v80
    v_cvt_pk_bf16_f32 v177, v90, v91
    v_cvt_pk_bf16_f32 v181, v92, v93
    v_cvt_pk_bf16_f32 v185, v94, v95
    v_cvt_pk_bf16_f32 v189, v96, v97
    s_waitcnt lgkmcnt(0)
    ds_read_b128 v[52:55], v28 offset:240
    v_mul_f32 v73, v49, v20
    v_mul_f32 v75, v49, v22
    v_mul_f32 v77, v49, v24
    v_mul_f32 v79, v49, v26
    v_mul_f32 v72, v48, v20
    v_mul_f32 v74, v48, v22
    v_mul_f32 v76, v48, v24
    v_mul_f32 v78, v48, v26
    v_fract_f32 v77, v77
    v_fract_f32 v79, v79
    v_cos_f32 v88, v73
    v_cos_f32 v90, v75
    v_cos_f32 v92, v77
    v_cos_f32 v94, v79
    v_sin_f32 v89, v73
    v_sin_f32 v91, v75
    v_sin_f32 v93, v77
    v_sin_f32 v95, v79
    v_exp_f32 v80, v72
    v_exp_f32 v82, v74
    v_exp_f32 v84, v76
    v_exp_f32 v86, v78
    v_mul_f32 v96, v50, v88
    v_mul_f32 v97, v50, v89
    v_fma_f32 v96, -v51, v89, v96
    v_fma_f32 v97, -v51, v88, -v97
    v_mul_f32 v90, v90, v82
    v_mul_f32 v91, v91, v82
    v_mul_f32 v92, v92, v84
    v_mul_f32 v93, v93, v84
    v_mul_f32 v94, v94, v86
    v_mul_f32 v95, v95, v86
    v_mul_f32 v96, v96, v80
    v_mul_f32 v97, v97, v80
    v_cvt_pk_bf16_f32 v178, v90, v91
    v_cvt_pk_bf16_f32 v182, v92, v93
    v_cvt_pk_bf16_f32 v186, v94, v95
    v_cvt_pk_bf16_f32 v190, v96, v97
    s_waitcnt lgkmcnt(0)
    v_mul_f32 v73, v53, v20
    v_mul_f32 v75, v53, v22
    v_mul_f32 v77, v53, v24
    v_mul_f32 v79, v53, v26
    v_mul_f32 v72, v52, v20
    v_mul_f32 v74, v52, v22
    v_mul_f32 v76, v52, v24
    v_mul_f32 v78, v52, v26
    v_fract_f32 v77, v77
    v_fract_f32 v79, v79
    v_cos_f32 v88, v73
    v_cos_f32 v90, v75
    v_cos_f32 v92, v77
    v_cos_f32 v94, v79
    v_sin_f32 v89, v73
    v_sin_f32 v91, v75
    v_sin_f32 v93, v77
    v_sin_f32 v95, v79
    v_exp_f32 v80, v72
    v_exp_f32 v82, v74
    v_exp_f32 v84, v76
    v_exp_f32 v86, v78
    v_mul_f32 v96, v54, v88
    v_mul_f32 v97, v54, v89
    v_fma_f32 v96, -v55, v89, v96
    v_fma_f32 v97, -v55, v88, -v97
    v_mul_f32 v90, v90, v82
    v_mul_f32 v91, v91, v82
    v_mul_f32 v92, v92, v84
    v_mul_f32 v93, v93, v84
    v_mul_f32 v94, v94, v86
    v_mul_f32 v95, v95, v86
    v_mul_f32 v96, v96, v80
    v_mul_f32 v97, v97, v80
    v_cvt_pk_bf16_f32 v179, v90, v91
    v_cvt_pk_bf16_f32 v183, v92, v93
    v_cvt_pk_bf16_f32 v187, v94, v95
    v_cvt_pk_bf16_f32 v191, v96, v97
    v_mfma_f32_16x16x32_bf16 v[32:35], v[128:131], v[140:143], 0
    v_mfma_f32_16x16x32_bf16 v[36:39], v[132:135], v[140:143], 0
    v_mfma_f32_16x16x32_bf16 v[40:43], v[136:139], v[140:143], 0
    v_mfma_f32_16x16x32_bf16 v[32:35], v[144:147], v[156:159], v[32:35]
    v_mfma_f32_16x16x32_bf16 v[36:39], v[148:151], v[156:159], v[36:39]
    v_mfma_f32_16x16x32_bf16 v[40:43], v[152:155], v[156:159], v[40:43]
    v_mfma_f32_16x16x32_bf16 v[32:35], v[160:163], v[172:175], v[32:35]
    v_mfma_f32_16x16x32_bf16 v[36:39], v[164:167], v[172:175], v[36:39]
    v_mfma_f32_16x16x32_bf16 v[40:43], v[168:171], v[172:175], v[40:43]
    v_mfma_f32_16x16x32_bf16 v[32:35], v[176:179], v[188:191], v[32:35]
    v_mfma_f32_16x16x32_bf16 v[36:39], v[180:183], v[188:191], v[36:39]
    v_mfma_f32_16x16x32_bf16 v[40:43], v[184:187], v[188:191], v[40:43]
    s_lshr_b32 s68, s101, 1
    s_mul_i32 s68, s68, 3072
    s_add_u32 s68, s68, 154624
    v_and_b32 v10, 15, v1
    v_lshrrev_b32 v11, 4, v1
    v_lshlrev_b32 v12, 3, v10
    v_and_b32 v13, 1, v11
    v_lshl_add_u32 v12, v13, 2, v12
    v_lshrrev_b32 v13, 1, v11
    v_lshl_add_u32 v12, v13, 7, v12
    v_lshlrev_b32 v12, 2, v12
    v_add_u32 v12, s68, v12
    v_lshlrev_b32 v13, 2, v10
    v_lshl_add_u32 v13, v11, 6, v13
    v_add_u32 v13, 256, v13
    v_lshlrev_b32 v14, 1, v10
    v_lshl_add_u32 v14, v11, 6, v14
    v_add_u32 v14, 256, v14
    v_cmp_gt_u32 vcc, 2, v11
    s_nop 1
    v_cndmask_b32 v13, v14, v13, vcc
    v_mov_b32 v15, 32
    v_cndmask_b32 v15, v15, 2, vcc
    v_add_u32 v14, v13, v15
    v_lshlrev_b32 v13, 2, v13
    v_lshlrev_b32 v14, 2, v14
    v_add_u32 v13, s68, v13
    v_add_u32 v14, s68, v14
    v_lshl_add_u32 v15, v11, 6, v10
    v_add_u32 v15, 512, v15
    v_lshlrev_b32 v15, 2, v15
    v_add_u32 v15, s68, v15
    s_bitcmp0_b32 s101, 0
    s_cbranch_scc1 L_tw_38
    ds_write_b128 v12, v[32:35]
    ds_write_b64 v13, v[36:37]
    ds_write_b64 v14, v[38:39]
    ds_write_b32 v15, v40 offset:0
    ds_write_b32 v15, v41 offset:64
    ds_write_b32 v15, v42 offset:128
    ds_write_b32 v15, v43 offset:192
    s_waitcnt lgkmcnt(0)
L_tw_38:
    s_barrier
    s_bitcmp1_b32 s101, 0
    s_cbranch_scc1 L_ta_39
    ds_read_b128 v[44:47], v12
    ds_read_b64 v[48:49], v13
    ds_read_b64 v[50:51], v14
    ds_read_b32 v52, v15 offset:0
    ds_read_b32 v53, v15 offset:64
    ds_read_b32 v54, v15 offset:128
    ds_read_b32 v55, v15 offset:192
    s_waitcnt lgkmcnt(0)
    v_add_f32 v32, v32, v44
    v_add_f32 v33, v33, v45
    v_add_f32 v34, v34, v46
    v_add_f32 v35, v35, v47
    v_add_f32 v36, v36, v48
    v_add_f32 v37, v37, v49
    v_add_f32 v38, v38, v50
    v_add_f32 v39, v39, v51
    v_add_f32 v40, v40, v52
    v_add_f32 v41, v41, v53
    v_add_f32 v42, v42, v54
    v_add_f32 v43, v43, v55
    ds_write_b128 v12, v[32:35]
    ds_write_b64 v13, v[36:37]
    ds_write_b64 v14, v[38:39]
    ds_write_b32 v15, v40 offset:0
    ds_write_b32 v15, v41 offset:64
    ds_write_b32 v15, v42 offset:128
    ds_write_b32 v15, v43 offset:192
    s_waitcnt lgkmcnt(0)
L_ta_39:
    s_lshr_b32 s68, s60, 6
    s_lshl_b32 s68, s68, 2
    s_add_u32 s68, s68, 11632640
    v_and_b32 v100, 31, v1
    v_lshlrev_b32 v100, 7, v100
    v_add_u32 v100, s68, v100
    buffer_load_dword v101, v100, s[52:55], 0 offen sc1
    s_barrier
    s_waitcnt vmcnt(0)
    v_cmp_ne_u32 vcc, s67, v101
    s_nop 4
    s_cbranch_vccz L_xf_40
    s_mov_b32 s100, 0
    s_mov_b64 s[82:83], exec
L_pf_41:
    buffer_load_dword v101, v100, s[52:55], 0 offen sc1
    s_waitcnt vmcnt(0)
    v_cmp_ne_u32 vcc, s67, v101
    s_add_u32 s100, s100, 1
    s_nop 3
    s_cbranch_vccz L_pfx_42
    s_cmp_lt_u32 s100, 30000
    s_cbranch_scc1 L_pf_41
L_pfx_42:
    s_mov_b64 exec, s[82:83]
L_xf_40:
    s_mul_i32 s70, s101, 4224
    s_add_u32 s70, s70, 114688
    s_lshr_b32 s72, s101, 1
    s_lshl_b32 s73, s60, 1
    s_add_u32 s72, s72, s73
    s_lshl_b32 s72, s72, 12
    s_and_b32 s73, s101, 1
    s_xor_b32 s73, s73, 1
    s_lshl_b32 s73, s73, 2
    s_add_u32 s72, s72, s73
    s_add_u32 s72, s72, 7340032
    v_lshlrev_b32 v10, 4, v1
    s_mov_b32 m0, s70
    s_nop 0
    buffer_load_dwordx4 v10, s[52:55], s72 offen offset:0 sc1 lds
    buffer_load_dwordx4 v10, s[52:55], s72 offen offset:1024 sc1 lds
    buffer_load_dwordx4 v10, s[52:55], s72 offen offset:2048 sc1 lds
    buffer_load_dwordx4 v10, s[52:55], s72 offen offset:3072 sc1 lds
    s_lshr_b32 s68, s101, 1
    s_and_b32 s69, s101, 1
    s_lshl_b32 s69, s69, 6
    v_add_u32 v10, s69, v1
    s_mul_i32 s70, s68, 3072
    s_add_u32 s70, s70, 156672
    v_lshlrev_b32 v11, 2, v10
    v_add_u32 v11, s70, v11
    ds_read_b32 v20, v11 offset:0
    ds_read_b32 v21, v11 offset:4
    v_add_u32 v12, 128, v10
    s_mul_i32 s70, s68, 11520
    v_mov_b32 v13, s70
    v_lshrrev_b32 v14, 2, v12
    v_mul_u32_u24 v14, 160, v14
    v_and_b32 v15, 3, v12
    v_lshl_add_u32 v14, v15, 4, v14
    v_add_u32 v14, 132864, v14
    v_add_u32 v14, v14, v13
    v_add_u32 v15, 72, v14
    v_and_b32 v16, 1, v10
    v_cmp_eq_u32 vcc, 0, v16
    s_waitcnt lgkmcnt(0)
    s_nop 0
    v_cndmask_b32 v22, v21, v20, vcc
    v_cvt_pk_bf16_f32 v44, v20, v20
    v_mov_b32 v45, v44
    v_cvt_pk_bf16_f32 v46, v22, v21
    v_cvt_pk_bf16_f32 v47, v21, v21
    v_mov_b32 v40, v44
    v_mov_b32 v41, v44
    v_cvt_pk_bf16_f32 v42, v20, v22
    v_mov_b32 v43, v47
    ds_write_b64 v14, v[40:41]
    ds_write_b64 v14, v[42:43] offset:8
    ds_write_b64 v15, v[44:45]
    ds_write_b64 v15, v[46:47] offset:8
    s_cmp_eq_u32 s101, 1
    s_cbranch_scc1 L_r1_43
    s_cmp_ge_u32 s101, 2
    s_cbranch_scc1 L_r2_44
    v_lshrrev_b32 v16, 5, v1
    v_and_b32 v12, 31, v1
    v_mul_u32_u24 v11, 3072, v16
    v_lshl_add_u32 v11, v12, 5, v11
    v_add_u32 v11, 154624, v11
    ds_read_b128 v[20:23], v11 offset:0
    ds_read_b128 v[24:27], v11 offset:16
    v_add_u32 v17, -4, v11
    ds_read_b32 v28, v17 offset:0
    v_mul_u32_u24 v13, 11520, v16
    v_lshrrev_b32 v14, 2, v12
    v_mul_u32_u24 v14, 160, v14
    v_and_b32 v15, 3, v12
    v_lshl_add_u32 v14, v15, 4, v14
    v_add_u32 v14, 132864, v14
    v_add_u32 v14, v14, v13
    v_add_u32 v15, 72, v14
    v_cmp_eq_u32 vcc, 0, v12
    s_waitcnt lgkmcnt(0)
    s_nop 0
    v_cndmask_b32 v28, v28, 0, vcc
    v_cvt_pk_bf16_f32 v44, v20, v21
    v_cvt_pk_bf16_f32 v45, v22, v23
    v_cvt_pk_bf16_f32 v46, v24, v25
    v_cvt_pk_bf16_f32 v47, v26, v27
    v_cvt_pk_bf16_f32 v40, v28, v20
    v_cvt_pk_bf16_f32 v41, v21, v22
    v_cvt_pk_bf16_f32 v42, v23, v24
    v_cvt_pk_bf16_f32 v43, v25, v26
    ds_write_b64 v14, v[40:41]
    ds_write_b64 v14, v[42:43] offset:8
    ds_write_b64 v15, v[44:45]
    ds_write_b64 v15, v[46:47] offset:8
    s_branch L_rx_45
L_r1_43:
    v_lshrrev_b32 v16, 5, v1
    v_and_b32 v12, 31, v1
    v_mul_u32_u24 v11, 3072, v16
    v_lshl_add_u32 v11, v12, 4, v11
    v_add_u32 v11, 155648, v11
    ds_read_b128 v[20:23], v11 offset:0
    ds_read_b32 v24, v11 offset:16
    v_add_u32 v17, -4, v11
    ds_read_b32 v28, v17 offset:0
    v_cmp_eq_u32 vcc, 0, v12
    v_add_u32 v12, 32, v12
    v_mul_u32_u24 v13, 11520, v16
    v_lshrrev_b32 v14, 2, v12
    v_mul_u32_u24 v14, 160, v14
    v_and_b32 v15, 3, v12
    v_lshl_add_u32 v14, v15, 4, v14
    v_add_u32 v14, 132864, v14
    v_add_u32 v14, v14, v13
    v_add_u32 v15, 72, v14
    s_waitcnt lgkmcnt(0)
    v_cndmask_b32 v28, v20, v28, vcc
    v_cvt_pk_bf16_f32 v44, v20, v20
    v_cvt_pk_bf16_f32 v45, v21, v22
    v_cvt_pk_bf16_f32 v46, v22, v22
    v_cvt_pk_bf16_f32 v47, v23, v24
    v_cvt_pk_bf16_f32 v40, v28, v20
    v_cvt_pk_bf16_f32 v41, v20, v21
    v_mov_b32 v42, v46
    v_cvt_pk_bf16_f32 v43, v22, v23
    ds_write_b64 v14, v[40:41]
    ds_write_b64 v14, v[42:43] offset:8
    ds_write_b64 v15, v[44:45]
    ds_write_b64 v15, v[46:47] offset:8
    s_branch L_rx_45
L_r2_44:
    s_sub_u32 s68, s101, 2
    s_mul_i32 s70, s68, 3072
    s_add_u32 s70, s70, 156160
    v_lshlrev_b32 v11, 3, v1
    v_add_u32 v11, s70, v11
    ds_read_b64 v[20:21], v11 offset:0
    ds_read_b32 v22, v11 offset:8
    v_add_u32 v12, 64, v1
    s_mul_i32 s70, s68, 11520
    v_mov_b32 v13, s70
    v_lshrrev_b32 v14, 2, v12
    v_mul_u32_u24 v14, 160, v14
    v_and_b32 v15, 3, v12
    v_lshl_add_u32 v14, v15, 4, v14
    v_add_u32 v14, 132864, v14
    v_add_u32 v14, v14, v13
    v_add_u32 v15, 72, v14
    s_waitcnt lgkmcnt(0)
    v_cvt_pk_bf16_f32 v44, v20, v20
    v_cvt_pk_bf16_f32 v45, v20, v21
    v_cvt_pk_bf16_f32 v46, v21, v21
    v_cvt_pk_bf16_f32 v47, v22, v22
    v_mov_b32 v40, v44
    v_mov_b32 v41, v44
    v_mov_b32 v42, v46
    v_cvt_pk_bf16_f32 v43, v21, v22
    ds_write_b64 v14, v[40:41]
    ds_write_b64 v14, v[42:43] offset:8
    ds_write_b64 v15, v[44:45]
    ds_write_b64 v15, v[46:47] offset:8
L_rx_45:
    s_waitcnt lgkmcnt(0)
    s_waitcnt vmcnt(0)
    s_mul_i32 s70, s101, 4224
    s_add_u32 s70, s70, 114688
    s_and_b32 s73, s101, 1
    s_lshl_b32 s73, s73, 2
    s_add_u32 s70, s70, s73
    s_add_u32 s70, s70, 4092
    v_lshlrev_b32 v10, 2, v1
    v_add_u32 v10, s70, v10
    v_mov_b32 v11, 0
    s_mov_b64 exec, 0xffffffff
    ds_write_b32 v10, v11
    s_mov_b64 exec, -1
    s_lshl_b32 s4, s85, 7
    s_mul_i32 s5, s101, 4
L_join1:
    s_waitcnt lgkmcnt(0)
    s_barrier
    v_mov_b32 v10, 160768
    ds_read_b32 v11, v10
    s_waitcnt lgkmcnt(0)
    v_readfirstlane_b32 s67, v11
    s_and_b32 s68, s61, 3
    s_lshr_b32 s69, s61, 2
    s_mul_i32 s69, s69, 7
    s_mul_i32 s3, s68, 28672
    s_lshl_b32 s71, s69, 11
    s_add_u32 s3, s3, s71
    s_mul_i32 s4, s68, 458752
    s_lshl_b32 s73, s85, 7
    s_add_u32 s4, s4, s73
    s_add_u32 s5, s69, 0
    s_bitcmp1_b32 s61, 1
    s_cbranch_scc1 L_cvb_46
    ds_read_b64 v[24:25], v246 offset:4032
    ds_read_b64 v[26:27], v246 offset:4040
    ds_read_b64 v[56:57], v247 offset:1280
    ds_read_b64 v[58:59], v247 offset:1288
    ds_read_b64 v[28:29], v246 offset:3520
    ds_read_b64 v[30:31], v246 offset:3528
    ds_read_b64 v[60:61], v247 offset:2560
    ds_read_b64 v[62:63], v247 offset:2568
    ds_read_b64 v[32:33], v246 offset:3008
    ds_read_b64 v[34:35], v246 offset:3016
    ds_read_b64 v[64:65], v247 offset:3840
    ds_read_b64 v[66:67], v247 offset:3848
    ds_read_b64 v[36:37], v246 offset:2496
    ds_read_b64 v[38:39], v246 offset:2504
    ds_read_b64 v[68:69], v247 offset:5120
    ds_read_b64 v[70:71], v247 offset:5128
    ds_read_b64 v[40:41], v246 offset:1984
    ds_read_b64 v[42:43], v246 offset:1992
    ds_read_b64 v[72:73], v247 offset:6400
    ds_read_b64 v[74:75], v247 offset:6408
    ds_read_b64 v[44:45], v246 offset:1472
    ds_read_b64 v[46:47], v246 offset:1480
    ds_read_b64 v[76:77], v247 offset:7680
    ds_read_b64 v[78:79], v247 offset:7688
    ds_read_b64 v[48:49], v246 offset:960
    ds_read_b64 v[50:51], v246 offset:968
    ds_read_b64 v[80:81], v247 offset:8960
    ds_read_b64 v[82:83], v247 offset:8968
    ds_read_b64 v[52:53], v246 offset:448
    ds_read_b64 v[54:55], v246 offset:456
    ds_read_b64 v[84:85], v247 offset:10240
    ds_read_b64 v[86:87], v247 offset:10248
    s_waitcnt lgkmcnt(15)
    v_mfma_f32_16x16x32_bf16 v[104:107], v[24:27], v[56:59], 0
    ds_read_b64 v[128:129], v246 offset:3968
    ds_read_b64 v[130:131], v246 offset:3976
    v_mfma_f32_16x16x32_bf16 v[108:111], v[28:31], v[64:67], 0
    ds_read_b64 v[160:161], v247 offset:1120
    ds_read_b64 v[162:163], v247 offset:1128
    s_add_u32 s6, s2, s5
    s_cmp_ge_u32 s6, 28
    s_cselect_b32 s7, 28, 0
    s_sub_u32 s6, s6, s7
    s_lshl_b32 s6, s6, 14
    s_add_u32 s6, s6, s4
    s_add_u32 m0, s3, 0
    s_add_u32 s5, s5, 1
    buffer_load_dwordx4 v243, s[48:51], s6 offen lds
    v_mfma_f32_16x16x32_bf16 v[108:111], v[32:35], v[60:63], v[108:111]
    ds_read_b64 v[132:133], v246 offset:3456
    ds_read_b64 v[134:135], v246 offset:3464
    v_mfma_f32_16x16x32_bf16 v[112:115], v[32:35], v[64:67], 0
    ds_read_b64 v[164:165], v247 offset:2400
    ds_read_b64 v[166:167], v247 offset:2408
    s_add_u32 m0, s3, 1024
    s_add_u32 s6, s6, 8192
    buffer_load_dwordx4 v243, s[48:51], s6 offen lds
    v_mfma_f32_16x16x32_bf16 v[108:111], v[24:27], v[68:71], v[108:111]
    ds_read_b64 v[136:137], v246 offset:2944
    ds_read_b64 v[138:139], v246 offset:2952
    v_mfma_f32_16x16x32_bf16 v[108:111], v[36:39], v[56:59], v[108:111]
    ds_read_b64 v[168:169], v247 offset:3680
    ds_read_b64 v[170:171], v247 offset:3688
    s_add_u32 s6, s2, s5
    s_cmp_ge_u32 s6, 28
    s_cselect_b32 s7, 28, 0
    s_sub_u32 s6, s6, s7
    s_lshl_b32 s6, s6, 14
    s_add_u32 s6, s6, s4
    s_add_u32 m0, s3, 2048
    s_add_u32 s5, s5, 1
    buffer_load_dwordx4 v243, s[48:51], s6 offen lds
    v_mfma_f32_16x16x32_bf16 v[112:115], v[28:31], v[68:71], v[112:115]
    ds_read_b64 v[140:141], v246 offset:2432
    ds_read_b64 v[142:143], v246 offset:2440
    v_mfma_f32_16x16x32_bf16 v[112:115], v[36:39], v[60:63], v[112:115]
    ds_read_b64 v[172:173], v247 offset:4960
    ds_read_b64 v[174:175], v247 offset:4968
    s_add_u32 m0, s3, 3072
    s_add_u32 s6, s6, 8192
    buffer_load_dwordx4 v243, s[48:51], s6 offen lds
    s_waitcnt lgkmcnt(15)
    v_mfma_f32_16x16x32_bf16 v[112:115], v[24:27], v[72:75], v[112:115]
    ds_read_b64 v[144:145], v246 offset:1920
    ds_read_b64 v[146:147], v246 offset:1928
    v_mfma_f32_16x16x32_bf16 v[112:115], v[40:43], v[56:59], v[112:115]
    ds_read_b64 v[176:177], v247 offset:6240
    ds_read_b64 v[178:179], v247 offset:6248
    s_add_u32 s6, s2, s5
    s_cmp_ge_u32 s6, 28
    s_cselect_b32 s7, 28, 0
    s_sub_u32 s6, s6, s7
    s_lshl_b32 s6, s6, 14
    s_add_u32 s6, s6, s4
    s_add_u32 m0, s3, 4096
    s_add_u32 s5, s5, 1
    buffer_load_dwordx4 v243, s[48:51], s6 offen lds
    v_mfma_f32_16x16x32_bf16 v[116:119], v[36:39], v[72:75], 0
    ds_read_b64 v[148:149], v246 offset:1408
    ds_read_b64 v[150:151], v246 offset:1416
    v_mfma_f32_16x16x32_bf16 v[116:119], v[40:43], v[68:71], v[116:119]
    ds_read_b64 v[180:181], v247 offset:7520
    ds_read_b64 v[182:183], v247 offset:7528
    s_add_u32 m0, s3, 5120
    s_add_u32 s6, s6, 8192
    buffer_load_dwordx4 v243, s[48:51], s6 offen lds
    v_mfma_f32_16x16x32_bf16 v[116:119], v[32:35], v[76:79], v[116:119]
    ds_read_b64 v[152:153], v246 offset:896
    ds_read_b64 v[154:155], v246 offset:904
    v_mfma_f32_16x16x32_bf16 v[116:119], v[44:47], v[64:67], v[116:119]
    ds_read_b64 v[184:185], v247 offset:8800
    ds_read_b64 v[186:187], v247 offset:8808
    s_add_u32 s6, s2, s5
    s_cmp_ge_u32 s6, 28
    s_cselect_b32 s7, 28, 0
    s_sub_u32 s6, s6, s7
    s_lshl_b32 s6, s6, 14
    s_add_u32 s6, s6, s4
    s_add_u32 m0, s3, 6144
    s_add_u32 s5, s5, 1
    buffer_load_dwordx4 v243, s[48:51], s6 offen lds
    v_mfma_f32_16x16x32_bf16 v[116:119], v[28:31], v[80:83], v[116:119]
    ds_read_b64 v[156:157], v246 offset:384
    ds_read_b64 v[158:159], v246 offset:392
    v_mfma_f32_16x16x32_bf16 v[116:119], v[48:51], v[60:63], v[116:119]
    ds_read_b64 v[188:189], v247 offset:10080
    ds_read_b64 v[190:191], v247 offset:10088
    s_add_u32 m0, s3, 7168
    s_add_u32 s6, s6, 8192
    buffer_load_dwordx4 v243, s[48:51], s6 offen lds
    v_mfma_f32_16x16x32_bf16 v[116:119], v[24:27], v[84:87], v[116:119]
    v_mfma_f32_16x16x32_bf16 v[116:119], v[52:55], v[56:59], v[116:119]
    s_add_u32 s6, s2, s5
    s_cmp_ge_u32 s6, 28
    s_cselect_b32 s7, 28, 0
    s_sub_u32 s6, s6, s7
    s_lshl_b32 s6, s6, 14
    s_add_u32 s6, s6, s4
    s_add_u32 m0, s3, 8192
    s_add_u32 s5, s5, 1
    buffer_load_dwordx4 v243, s[48:51], s6 offen lds
    s_waitcnt lgkmcnt(15)
    v_mfma_f32_16x16x32_bf16 v[104:107], v[128:131], v[160:163], v[104:107]
    ds_read_b64 v[24:25], v246 offset:3904
    ds_read_b64 v[26:27], v246 offset:3912
    v_mfma_f32_16x16x32_bf16 v[108:111], v[132:135], v[168:171], v[108:111]
    ds_read_b64 v[56:57], v247 offset:960
    ds_read_b64 v[58:59], v247 offset:968
    s_add_u32 m0, s3, 9216
    s_add_u32 s6, s6, 8192
    buffer_load_dwordx4 v243, s[48:51], s6 offen lds
    v_mfma_f32_16x16x32_bf16 v[108:111], v[136:139], v[164:167], v[108:111]
    ds_read_b64 v[28:29], v246 offset:3392
    ds_read_b64 v[30:31], v246 offset:3400
    v_mfma_f32_16x16x32_bf16 v[112:115], v[136:139], v[168:171], v[112:115]
    ds_read_b64 v[60:61], v247 offset:2240
    ds_read_b64 v[62:63], v247 offset:2248
    s_add_u32 s6, s2, s5
    s_cmp_ge_u32 s6, 28
    s_cselect_b32 s7, 28, 0
    s_sub_u32 s6, s6, s7
    s_lshl_b32 s6, s6, 14
    s_add_u32 s6, s6, s4
    s_add_u32 m0, s3, 10240
    s_add_u32 s5, s5, 1
    buffer_load_dwordx4 v243, s[48:51], s6 offen lds
    v_mfma_f32_16x16x32_bf16 v[108:111], v[128:131], v[172:175], v[108:111]
    ds_read_b64 v[32:33], v246 offset:2880
    ds_read_b64 v[34:35], v246 offset:2888
    v_mfma_f32_16x16x32_bf16 v[108:111], v[140:143], v[160:163], v[108:111]
    ds_read_b64 v[64:65], v247 offset:3520
    ds_read_b64 v[66:67], v247 offset:3528
    s_add_u32 m0, s3, 11264
    s_add_u32 s6, s6, 8192
    buffer_load_dwordx4 v243, s[48:51], s6 offen lds
    v_mfma_f32_16x16x32_bf16 v[112:115], v[132:135], v[172:175], v[112:115]
    ds_read_b64 v[36:37], v246 offset:2368
    ds_read_b64 v[38:39], v246 offset:2376
    v_mfma_f32_16x16x32_bf16 v[112:115], v[140:143], v[164:167], v[112:115]
    ds_read_b64 v[68:69], v247 offset:4800
    ds_read_b64 v[70:71], v247 offset:4808
    s_add_u32 s6, s2, s5
    s_cmp_ge_u32 s6, 28
    s_cselect_b32 s7, 28, 0
    s_sub_u32 s6, s6, s7
    s_lshl_b32 s6, s6, 14
    s_add_u32 s6, s6, s4
    s_add_u32 m0, s3, 12288
    s_add_u32 s5, s5, 1
    buffer_load_dwordx4 v243, s[48:51], s6 offen lds
    s_waitcnt lgkmcnt(15)
    v_mfma_f32_16x16x32_bf16 v[112:115], v[128:131], v[176:179], v[112:115]
    ds_read_b64 v[40:41], v246 offset:1856
    ds_read_b64 v[42:43], v246 offset:1864
    v_mfma_f32_16x16x32_bf16 v[112:115], v[144:147], v[160:163], v[112:115]
    ds_read_b64 v[72:73], v247 offset:6080
    ds_read_b64 v[74:75], v247 offset:6088
    s_add_u32 m0, s3, 13312
    s_add_u32 s6, s6, 8192
    buffer_load_dwordx4 v243, s[48:51], s6 offen lds
    v_mfma_f32_16x16x32_bf16 v[116:119], v[140:143], v[176:179], v[116:119]
    ds_read_b64 v[44:45], v246 offset:1344
    ds_read_b64 v[46:47], v246 offset:1352
    v_mfma_f32_16x16x32_bf16 v[116:119], v[144:147], v[172:175], v[116:119]
    ds_read_b64 v[76:77], v247 offset:7360
    ds_read_b64 v[78:79], v247 offset:7368
    v_mfma_f32_16x16x32_bf16 v[116:119], v[136:139], v[180:183], v[116:119]
    ds_read_b64 v[48:49], v246 offset:832
    ds_read_b64 v[50:51], v246 offset:840
    v_mfma_f32_16x16x32_bf16 v[116:119], v[148:151], v[168:171], v[116:119]
    ds_read_b64 v[80:81], v247 offset:8640
    ds_read_b64 v[82:83], v247 offset:8648
    v_mfma_f32_16x16x32_bf16 v[116:119], v[132:135], v[184:187], v[116:119]
    ds_read_b64 v[52:53], v246 offset:320
    ds_read_b64 v[54:55], v246 offset:328
    v_mfma_f32_16x16x32_bf16 v[116:119], v[152:155], v[164:167], v[116:119]
    ds_read_b64 v[84:85], v247 offset:9920
    ds_read_b64 v[86:87], v247 offset:9928
    v_mfma_f32_16x16x32_bf16 v[116:119], v[128:131], v[188:191], v[116:119]
    v_mfma_f32_16x16x32_bf16 v[116:119], v[156:159], v[160:163], v[116:119]
    s_waitcnt lgkmcnt(15)
    v_mfma_f32_16x16x32_bf16 v[104:107], v[24:27], v[56:59], v[104:107]
    ds_read_b64 v[128:129], v246 offset:3840
    ds_read_b64 v[130:131], v246 offset:3848
    v_mfma_f32_16x16x32_bf16 v[108:111], v[28:31], v[64:67], v[108:111]
    ds_read_b64 v[160:161], v247 offset:800
    ds_read_b64 v[162:163], v247 offset:808
    v_mfma_f32_16x16x32_bf16 v[108:111], v[32:35], v[60:63], v[108:111]
    ds_read_b64 v[132:133], v246 offset:3328
    ds_read_b64 v[134:135], v246 offset:3336
    v_mfma_f32_16x16x32_bf16 v[112:115], v[32:35], v[64:67], v[112:115]
    ds_read_b64 v[164:165], v247 offset:2080
    ds_read_b64 v[166:167], v247 offset:2088
    v_mfma_f32_16x16x32_bf16 v[108:111], v[24:27], v[68:71], v[108:111]
    ds_read_b64 v[136:137], v246 offset:2816
    ds_read_b64 v[138:139], v246 offset:2824
    v_mfma_f32_16x16x32_bf16 v[108:111], v[36:39], v[56:59], v[108:111]
    ds_read_b64 v[168:169], v247 offset:3360
    ds_read_b64 v[170:171], v247 offset:3368
    v_mfma_f32_16x16x32_bf16 v[112:115], v[28:31], v[68:71], v[112:115]
    ds_read_b64 v[140:141], v246 offset:2304
    ds_read_b64 v[142:143], v246 offset:2312
    v_mfma_f32_16x16x32_bf16 v[112:115], v[36:39], v[60:63], v[112:115]
    ds_read_b64 v[172:173], v247 offset:4640
    ds_read_b64 v[174:175], v247 offset:4648
    s_waitcnt lgkmcnt(15)
    v_mfma_f32_16x16x32_bf16 v[112:115], v[24:27], v[72:75], v[112:115]
    ds_read_b64 v[144:145], v246 offset:1792
    ds_read_b64 v[146:147], v246 offset:1800
    v_mfma_f32_16x16x32_bf16 v[112:115], v[40:43], v[56:59], v[112:115]
    ds_read_b64 v[176:177], v247 offset:5920
    ds_read_b64 v[178:179], v247 offset:5928
    v_mfma_f32_16x16x32_bf16 v[116:119], v[36:39], v[72:75], v[116:119]
    ds_read_b64 v[148:149], v246 offset:1280
    ds_read_b64 v[150:151], v246 offset:1288
    v_mfma_f32_16x16x32_bf16 v[116:119], v[40:43], v[68:71], v[116:119]
    ds_read_b64 v[180:181], v247 offset:7200
    ds_read_b64 v[182:183], v247 offset:7208
    v_mfma_f32_16x16x32_bf16 v[116:119], v[32:35], v[76:79], v[116:119]
    ds_read_b64 v[152:153], v246 offset:768
    ds_read_b64 v[154:155], v246 offset:776
    v_mfma_f32_16x16x32_bf16 v[116:119], v[44:47], v[64:67], v[116:119]
    ds_read_b64 v[184:185], v247 offset:8480
    ds_read_b64 v[186:187], v247 offset:8488
    v_mfma_f32_16x16x32_bf16 v[116:119], v[28:31], v[80:83], v[116:119]
    ds_read_b64 v[156:157], v246 offset:256
    ds_read_b64 v[158:159], v246 offset:264
    v_mfma_f32_16x16x32_bf16 v[116:119], v[48:51], v[60:63], v[116:119]
    ds_read_b64 v[188:189], v247 offset:9760
    ds_read_b64 v[190:191], v247 offset:9768
    v_mfma_f32_16x16x32_bf16 v[116:119], v[24:27], v[84:87], v[116:119]
    v_mfma_f32_16x16x32_bf16 v[116:119], v[52:55], v[56:59], v[116:119]
    s_waitcnt lgkmcnt(15)
    v_mfma_f32_16x16x32_bf16 v[104:107], v[128:131], v[160:163], v[104:107]
    v_mfma_f32_16x16x32_bf16 v[108:111], v[132:135], v[168:171], v[108:111]
    v_mfma_f32_16x16x32_bf16 v[108:111], v[136:139], v[164:167], v[108:111]
    v_mfma_f32_16x16x32_bf16 v[112:115], v[136:139], v[168:171], v[112:115]
    v_mfma_f32_16x16x32_bf16 v[108:111], v[128:131], v[172:175], v[108:111]
    v_mfma_f32_16x16x32_bf16 v[108:111], v[140:143], v[160:163], v[108:111]
    v_mfma_f32_16x16x32_bf16 v[112:115], v[132:135], v[172:175], v[112:115]
    v_mfma_f32_16x16x32_bf16 v[112:115], v[140:143], v[164:167], v[112:115]
    s_waitcnt lgkmcnt(12)
    v_mfma_f32_16x16x32_bf16 v[112:115], v[128:131], v[176:179], v[112:115]
    v_mfma_f32_16x16x32_bf16 v[112:115], v[144:147], v[160:163], v[112:115]
    v_mfma_f32_16x16x32_bf16 v[116:119], v[140:143], v[176:179], v[116:119]
    v_mfma_f32_16x16x32_bf16 v[116:119], v[144:147], v[172:175], v[116:119]
    s_waitcnt lgkmcnt(8)
    v_mfma_f32_16x16x32_bf16 v[116:119], v[136:139], v[180:183], v[116:119]
    v_mfma_f32_16x16x32_bf16 v[116:119], v[148:151], v[168:171], v[116:119]
    s_waitcnt lgkmcnt(4)
    v_mfma_f32_16x16x32_bf16 v[116:119], v[132:135], v[184:187], v[116:119]
    v_mfma_f32_16x16x32_bf16 v[116:119], v[152:155], v[164:167], v[116:119]
    s_waitcnt lgkmcnt(0)
    v_mfma_f32_16x16x32_bf16 v[116:119], v[128:131], v[188:191], v[116:119]
    v_mfma_f32_16x16x32_bf16 v[116:119], v[156:159], v[160:163], v[116:119]
    s_branch L_cve_47
L_cvb_46:
    ds_read_b64 v[24:25], v246 offset:4032
    ds_read_b64 v[26:27], v246 offset:4040
    ds_read_b64 v[56:57], v247 offset:1280
    ds_read_b64 v[58:59], v247 offset:1288
    ds_read_b64 v[28:29], v246 offset:3520
    ds_read_b64 v[30:31], v246 offset:3528
    ds_read_b64 v[60:61], v247 offset:2560
    ds_read_b64 v[62:63], v247 offset:2568
    ds_read_b64 v[32:33], v246 offset:3008
    ds_read_b64 v[34:35], v246 offset:3016
    ds_read_b64 v[64:65], v247 offset:3840
    ds_read_b64 v[66:67], v247 offset:3848
    ds_read_b64 v[36:37], v246 offset:2496
    ds_read_b64 v[38:39], v246 offset:2504
    ds_read_b64 v[68:69], v247 offset:5120
    ds_read_b64 v[70:71], v247 offset:5128
    ds_read_b64 v[40:41], v246 offset:1984
    ds_read_b64 v[42:43], v246 offset:1992
    ds_read_b64 v[72:73], v247 offset:6400
    ds_read_b64 v[74:75], v247 offset:6408
    ds_read_b64 v[44:45], v246 offset:1472
    ds_read_b64 v[46:47], v246 offset:1480
    ds_read_b64 v[76:77], v247 offset:7680
    ds_read_b64 v[78:79], v247 offset:7688
    ds_read_b64 v[48:49], v246 offset:960
    ds_read_b64 v[50:51], v246 offset:968
    ds_read_b64 v[80:81], v247 offset:8960
    ds_read_b64 v[82:83], v247 offset:8968
    s_waitcnt lgkmcnt(15)
    v_mfma_f32_16x16x32_bf16 v[104:107], v[24:27], v[60:63], 0
    ds_read_b64 v[128:129], v246 offset:3968
    ds_read_b64 v[130:131], v246 offset:3976
    v_mfma_f32_16x16x32_bf16 v[104:107], v[28:31], v[56:59], v[104:107]
    ds_read_b64 v[160:161], v247 offset:1120
    ds_read_b64 v[162:163], v247 offset:1128
    s_add_u32 s6, s2, s5
    s_cmp_ge_u32 s6, 28
    s_cselect_b32 s7, 28, 0
    s_sub_u32 s6, s6, s7
    s_lshl_b32 s6, s6, 14
    s_add_u32 s6, s6, s4
    s_add_u32 m0, s3, 0
    s_add_u32 s5, s5, 1
    buffer_load_dwordx4 v243, s[48:51], s6 offen lds
    v_mfma_f32_16x16x32_bf16 v[108:111], v[28:31], v[60:63], 0
    ds_read_b64 v[132:133], v246 offset:3456
    ds_read_b64 v[134:135], v246 offset:3464
    v_mfma_f32_16x16x32_bf16 v[108:111], v[24:27], v[64:67], v[108:111]
    ds_read_b64 v[164:165], v247 offset:2400
    ds_read_b64 v[166:167], v247 offset:2408
    s_add_u32 m0, s3, 1024
    s_add_u32 s6, s6, 8192
    buffer_load_dwordx4 v243, s[48:51], s6 offen lds
    v_mfma_f32_16x16x32_bf16 v[108:111], v[32:35], v[56:59], v[108:111]
    ds_read_b64 v[136:137], v246 offset:2944
    ds_read_b64 v[138:139], v246 offset:2952
    s_waitcnt lgkmcnt(15)
    v_mfma_f32_16x16x32_bf16 v[112:115], v[32:35], v[68:71], 0
    ds_read_b64 v[168:169], v247 offset:3680
    ds_read_b64 v[170:171], v247 offset:3688
    s_add_u32 s6, s2, s5
    s_cmp_ge_u32 s6, 28
    s_cselect_b32 s7, 28, 0
    s_sub_u32 s6, s6, s7
    s_lshl_b32 s6, s6, 14
    s_add_u32 s6, s6, s4
    s_add_u32 m0, s3, 2048
    s_add_u32 s5, s5, 1
    buffer_load_dwordx4 v243, s[48:51], s6 offen lds
    v_mfma_f32_16x16x32_bf16 v[112:115], v[36:39], v[64:67], v[112:115]
    ds_read_b64 v[140:141], v246 offset:2432
    ds_read_b64 v[142:143], v246 offset:2440
    v_mfma_f32_16x16x32_bf16 v[116:119], v[36:39], v[68:71], 0
    ds_read_b64 v[172:173], v247 offset:4960
    ds_read_b64 v[174:175], v247 offset:4968
    s_add_u32 m0, s3, 3072
    s_add_u32 s6, s6, 8192
    buffer_load_dwordx4 v243, s[48:51], s6 offen lds
    v_mfma_f32_16x16x32_bf16 v[112:115], v[28:31], v[72:75], v[112:115]
    ds_read_b64 v[144:145], v246 offset:1920
    ds_read_b64 v[146:147], v246 offset:1928
    v_mfma_f32_16x16x32_bf16 v[112:115], v[40:43], v[60:63], v[112:115]
    ds_read_b64 v[176:177], v247 offset:6240
    ds_read_b64 v[178:179], v247 offset:6248
    s_add_u32 s6, s2, s5
    s_cmp_ge_u32 s6, 28
    s_cselect_b32 s7, 28, 0
    s_sub_u32 s6, s6, s7
    s_lshl_b32 s6, s6, 14
    s_add_u32 s6, s6, s4
    s_add_u32 m0, s3, 4096
    s_add_u32 s5, s5, 1
    buffer_load_dwordx4 v243, s[48:51], s6 offen lds
    v_mfma_f32_16x16x32_bf16 v[116:119], v[32:35], v[72:75], v[116:119]
    ds_read_b64 v[148:149], v246 offset:1408
    ds_read_b64 v[150:151], v246 offset:1416
    v_mfma_f32_16x16x32_bf16 v[116:119], v[40:43], v[64:67], v[116:119]
    ds_read_b64 v[180:181], v247 offset:7520
    ds_read_b64 v[182:183], v247 offset:7528
    s_add_u32 m0, s3, 5120
    s_add_u32 s6, s6, 8192
    buffer_load_dwordx4 v243, s[48:51], s6 offen lds
    s_waitcnt lgkmcnt(15)
    v_mfma_f32_16x16x32_bf16 v[112:115], v[24:27], v[76:79], v[112:115]
    ds_read_b64 v[152:153], v246 offset:896
    ds_read_b64 v[154:155], v246 offset:904
    v_mfma_f32_16x16x32_bf16 v[112:115], v[44:47], v[56:59], v[112:115]
    ds_read_b64 v[184:185], v247 offset:8800
    ds_read_b64 v[186:187], v247 offset:8808
    s_add_u32 s6, s2, s5
    s_cmp_ge_u32 s6, 28
    s_cselect_b32 s7, 28, 0
    s_sub_u32 s6, s6, s7
    s_lshl_b32 s6, s6, 14
    s_add_u32 s6, s6, s4
    s_add_u32 m0, s3, 6144
    s_add_u32 s5, s5, 1
    buffer_load_dwordx4 v243, s[48:51], s6 offen lds
    v_mfma_f32_16x16x32_bf16 v[116:119], v[28:31], v[76:79], v[116:119]
    v_mfma_f32_16x16x32_bf16 v[116:119], v[44:47], v[60:63], v[116:119]
    s_add_u32 m0, s3, 7168
    s_add_u32 s6, s6, 8192
    buffer_load_dwordx4 v243, s[48:51], s6 offen lds
    v_mfma_f32_16x16x32_bf16 v[116:119], v[24:27], v[80:83], v[116:119]
    v_mfma_f32_16x16x32_bf16 v[116:119], v[48:51], v[56:59], v[116:119]
    s_add_u32 s6, s2, s5
    s_cmp_ge_u32 s6, 28
    s_cselect_b32 s7, 28, 0
    s_sub_u32 s6, s6, s7
    s_lshl_b32 s6, s6, 14
    s_add_u32 s6, s6, s4
    s_add_u32 m0, s3, 8192
    s_add_u32 s5, s5, 1
    buffer_load_dwordx4 v243, s[48:51], s6 offen lds
    v_mfma_f32_16x16x32_bf16 v[104:107], v[128:131], v[164:167], v[104:107]
    ds_read_b64 v[24:25], v246 offset:3904
    ds_read_b64 v[26:27], v246 offset:3912
    v_mfma_f32_16x16x32_bf16 v[104:107], v[132:135], v[160:163], v[104:107]
    ds_read_b64 v[56:57], v247 offset:960
    ds_read_b64 v[58:59], v247 offset:968
    s_add_u32 m0, s3, 9216
    s_add_u32 s6, s6, 8192
    buffer_load_dwordx4 v243, s[48:51], s6 offen lds
    v_mfma_f32_16x16x32_bf16 v[108:111], v[132:135], v[164:167], v[108:111]
    ds_read_b64 v[28:29], v246 offset:3392
    ds_read_b64 v[30:31], v246 offset:3400
    s_waitcnt lgkmcnt(15)
    v_mfma_f32_16x16x32_bf16 v[108:111], v[128:131], v[168:171], v[108:111]
    ds_read_b64 v[60:61], v247 offset:2240
    ds_read_b64 v[62:63], v247 offset:2248
    s_add_u32 s6, s2, s5
    s_cmp_ge_u32 s6, 28
    s_cselect_b32 s7, 28, 0
    s_sub_u32 s6, s6, s7
    s_lshl_b32 s6, s6, 14
    s_add_u32 s6, s6, s4
    s_add_u32 m0, s3, 10240
    s_add_u32 s5, s5, 1
    buffer_load_dwordx4 v243, s[48:51], s6 offen lds
    v_mfma_f32_16x16x32_bf16 v[108:111], v[136:139], v[160:163], v[108:111]
    ds_read_b64 v[32:33], v246 offset:2880
    ds_read_b64 v[34:35], v246 offset:2888
    v_mfma_f32_16x16x32_bf16 v[112:115], v[136:139], v[172:175], v[112:115]
    ds_read_b64 v[64:65], v247 offset:3520
    ds_read_b64 v[66:67], v247 offset:3528
    s_add_u32 m0, s3, 11264
    s_add_u32 s6, s6, 8192
    buffer_load_dwordx4 v243, s[48:51], s6 offen lds
    v_mfma_f32_16x16x32_bf16 v[112:115], v[140:143], v[168:171], v[112:115]
    ds_read_b64 v[36:37], v246 offset:2368
    ds_read_b64 v[38:39], v246 offset:2376
    v_mfma_f32_16x16x32_bf16 v[116:119], v[140:143], v[172:175], v[116:119]
    ds_read_b64 v[68:69], v247 offset:4800
    ds_read_b64 v[70:71], v247 offset:4808
    s_add_u32 s6, s2, s5
    s_cmp_ge_u32 s6, 28
    s_cselect_b32 s7, 28, 0
    s_sub_u32 s6, s6, s7
    s_lshl_b32 s6, s6, 14
    s_add_u32 s6, s6, s4
    s_add_u32 m0, s3, 12288
    s_add_u32 s5, s5, 1
    buffer_load_dwordx4 v243, s[48:51], s6 offen lds
    s_waitcnt lgkmcnt(15)
    v_mfma_f32_16x16x32_bf16 v[112:115], v[132:135], v[176:179], v[112:115]
    ds_read_b64 v[40:41], v246 offset:1856
    ds_read_b64 v[42:43], v246 offset:1864
    v_mfma_f32_16x16x32_bf16 v[112:115], v[144:147], v[164:167], v[112:115]
    ds_read_b64 v[72:73], v247 offset:6080
    ds_read_b64 v[74:75], v247 offset:6088
    s_add_u32 m0, s3, 13312
    s_add_u32 s6, s6, 8192
    buffer_load_dwordx4 v243, s[48:51], s6 offen lds
    v_mfma_f32_16x16x32_bf16 v[116:119], v[136:139], v[176:179], v[116:119]
    ds_read_b64 v[44:45], v246 offset:1344
    ds_read_b64 v[46:47], v246 offset:1352
    v_mfma_f32_16x16x32_bf16 v[116:119], v[144:147], v[168:171], v[116:119]
    ds_read_b64 v[76:77], v247 offset:7360
    ds_read_b64 v[78:79], v247 offset:7368
    v_mfma_f32_16x16x32_bf16 v[112:115], v[128:131], v[180:183], v[112:115]
    ds_read_b64 v[48:49], v246 offset:832
    ds_read_b64 v[50:51], v246 offset:840
    v_mfma_f32_16x16x32_bf16 v[112:115], v[148:151], v[160:163], v[112:115]
    ds_read_b64 v[80:81], v247 offset:8640
    ds_read_b64 v[82:83], v247 offset:8648
    v_mfma_f32_16x16x32_bf16 v[116:119], v[132:135], v[180:183], v[116:119]
    v_mfma_f32_16x16x32_bf16 v[116:119], v[148:151], v[164:167], v[116:119]
    v_mfma_f32_16x16x32_bf16 v[116:119], v[128:131], v[184:187], v[116:119]
    v_mfma_f32_16x16x32_bf16 v[116:119], v[152:155], v[160:163], v[116:119]
    s_waitcnt lgkmcnt(15)
    v_mfma_f32_16x16x32_bf16 v[104:107], v[24:27], v[60:63], v[104:107]
    ds_read_b64 v[128:129], v246 offset:3840
    ds_read_b64 v[130:131], v246 offset:3848
    v_mfma_f32_16x16x32_bf16 v[104:107], v[28:31], v[56:59], v[104:107]
    ds_read_b64 v[160:161], v247 offset:800
    ds_read_b64 v[162:163], v247 offset:808
    v_mfma_f32_16x16x32_bf16 v[108:111], v[28:31], v[60:63], v[108:111]
    ds_read_b64 v[132:133], v246 offset:3328
    ds_read_b64 v[134:135], v246 offset:3336
    v_mfma_f32_16x16x32_bf16 v[108:111], v[24:27], v[64:67], v[108:111]
    ds_read_b64 v[164:165], v247 offset:2080
    ds_read_b64 v[166:167], v247 offset:2088
    v_mfma_f32_16x16x32_bf16 v[108:111], v[32:35], v[56:59], v[108:111]
    ds_read_b64 v[136:137], v246 offset:2816
    ds_read_b64 v[138:139], v246 offset:2824
    s_waitcnt lgkmcnt(15)
    v_mfma_f32_16x16x32_bf16 v[112:115], v[32:35], v[68:71], v[112:115]
    ds_read_b64 v[168:169], v247 offset:3360
    ds_read_b64 v[170:171], v247 offset:3368
    v_mfma_f32_16x16x32_bf16 v[112:115], v[36:39], v[64:67], v[112:115]
    ds_read_b64 v[140:141], v246 offset:2304
    ds_read_b64 v[142:143], v246 offset:2312
    v_mfma_f32_16x16x32_bf16 v[116:119], v[36:39], v[68:71], v[116:119]
    ds_read_b64 v[172:173], v247 offset:4640
    ds_read_b64 v[174:175], v247 offset:4648
    v_mfma_f32_16x16x32_bf16 v[112:115], v[28:31], v[72:75], v[112:115]
    ds_read_b64 v[144:145], v246 offset:1792
    ds_read_b64 v[146:147], v246 offset:1800
    v_mfma_f32_16x16x32_bf16 v[112:115], v[40:43], v[60:63], v[112:115]
    ds_read_b64 v[176:177], v247 offset:5920
    ds_read_b64 v[178:179], v247 offset:5928
    v_mfma_f32_16x16x32_bf16 v[116:119], v[32:35], v[72:75], v[116:119]
    ds_read_b64 v[148:149], v246 offset:1280
    ds_read_b64 v[150:151], v246 offset:1288
    v_mfma_f32_16x16x32_bf16 v[116:119], v[40:43], v[64:67], v[116:119]
    ds_read_b64 v[180:181], v247 offset:7200
    ds_read_b64 v[182:183], v247 offset:7208
    s_waitcnt lgkmcnt(15)
    v_mfma_f32_16x16x32_bf16 v[112:115], v[24:27], v[76:79], v[112:115]
    ds_read_b64 v[152:153], v246 offset:768
    ds_read_b64 v[154:155], v246 offset:776
    v_mfma_f32_16x16x32_bf16 v[112:115], v[44:47], v[56:59], v[112:115]
    ds_read_b64 v[184:185], v247 offset:8480
    ds_read_b64 v[186:187], v247 offset:8488
    v_mfma_f32_16x16x32_bf16 v[116:119], v[28:31], v[76:79], v[116:119]
    v_mfma_f32_16x16x32_bf16 v[116:119], v[44:47], v[60:63], v[116:119]
    v_mfma_f32_16x16x32_bf16 v[116:119], v[24:27], v[80:83], v[116:119]
    v_mfma_f32_16x16x32_bf16 v[116:119], v[48:51], v[56:59], v[116:119]
    v_mfma_f32_16x16x32_bf16 v[104:107], v[128:131], v[164:167], v[104:107]
    v_mfma_f32_16x16x32_bf16 v[104:107], v[132:135], v[160:163], v[104:107]
    v_mfma_f32_16x16x32_bf16 v[108:111], v[132:135], v[164:167], v[108:111]
    s_waitcnt lgkmcnt(15)
    v_mfma_f32_16x16x32_bf16 v[108:111], v[128:131], v[168:171], v[108:111]
    v_mfma_f32_16x16x32_bf16 v[108:111], v[136:139], v[160:163], v[108:111]
    s_waitcnt lgkmcnt(12)
    v_mfma_f32_16x16x32_bf16 v[112:115], v[136:139], v[172:175], v[112:115]
    v_mfma_f32_16x16x32_bf16 v[112:115], v[140:143], v[168:171], v[112:115]
    v_mfma_f32_16x16x32_bf16 v[116:119], v[140:143], v[172:175], v[116:119]
    s_waitcnt lgkmcnt(8)
    v_mfma_f32_16x16x32_bf16 v[112:115], v[132:135], v[176:179], v[112:115]
    v_mfma_f32_16x16x32_bf16 v[112:115], v[144:147], v[164:167], v[112:115]
    v_mfma_f32_16x16x32_bf16 v[116:119], v[136:139], v[176:179], v[116:119]
    v_mfma_f32_16x16x32_bf16 v[116:119], v[144:147], v[168:171], v[116:119]
    s_waitcnt lgkmcnt(4)
    v_mfma_f32_16x16x32_bf16 v[112:115], v[128:131], v[180:183], v[112:115]
    v_mfma_f32_16x16x32_bf16 v[112:115], v[148:151], v[160:163], v[112:115]
    v_mfma_f32_16x16x32_bf16 v[116:119], v[132:135], v[180:183], v[116:119]
    v_mfma_f32_16x16x32_bf16 v[116:119], v[148:151], v[164:167], v[116:119]
    s_waitcnt lgkmcnt(0)
    v_mfma_f32_16x16x32_bf16 v[116:119], v[128:131], v[184:187], v[116:119]
    v_mfma_f32_16x16x32_bf16 v[116:119], v[152:155], v[160:163], v[116:119]
L_cve_47:
    s_waitcnt vmcnt(0)
    s_barrier
    buffer_load_dword v9, v252, s[52:55], 0 offen sc1
    ds_write_b128 v250, v[104:107] offset:0
    ds_write_b128 v250, v[108:111] offset:1024
    ds_write_b128 v250, v[112:115] offset:2048
    s_nop 0
    ds_write_b128 v250, v[116:119] offset:3072
    ds_read_b64_tr_b16 v[128:129], v240 offset:0
    ds_read_b64_tr_b16 v[130:131], v240 offset:512
    ds_read_b64_tr_b16 v[132:133], v241 offset:0
    ds_read_b64_tr_b16 v[134:135], v241 offset:512
    ds_read_b64_tr_b16 v[136:137], v240 offset:2048
    ds_read_b64_tr_b16 v[138:139], v240 offset:2560
    ds_read_b64_tr_b16 v[140:141], v241 offset:2048
    ds_read_b64_tr_b16 v[142:143], v241 offset:2560
    ds_read_b64_tr_b16 v[144:145], v240 offset:4096
    ds_read_b64_tr_b16 v[146:147], v240 offset:4608
    ds_read_b64_tr_b16 v[148:149], v241 offset:4096
    ds_read_b64_tr_b16 v[150:151], v241 offset:4608
    ds_read_b64_tr_b16 v[152:153], v240 offset:6144
    ds_read_b64_tr_b16 v[154:155], v240 offset:6656
    ds_read_b64_tr_b16 v[156:157], v241 offset:6144
    ds_read_b64_tr_b16 v[158:159], v241 offset:6656
    ds_read_b64_tr_b16 v[160:161], v240 offset:8192
    ds_read_b64_tr_b16 v[162:163], v240 offset:8704
    ds_read_b64_tr_b16 v[164:165], v241 offset:8192
    ds_read_b64_tr_b16 v[166:167], v241 offset:8704
    ds_read_b64_tr_b16 v[168:169], v240 offset:10240
    ds_read_b64_tr_b16 v[170:171], v240 offset:10752
    ds_read_b64_tr_b16 v[172:173], v241 offset:10240
    ds_read_b64_tr_b16 v[174:175], v241 offset:10752
    ds_read_b64_tr_b16 v[176:177], v240 offset:12288
    ds_read_b64_tr_b16 v[178:179], v240 offset:12800
    ds_read_b64_tr_b16 v[180:181], v241 offset:12288
    ds_read_b64_tr_b16 v[182:183], v241 offset:12800
    ds_read_b64_tr_b16 v[184:185], v240 offset:14336
    ds_read_b64_tr_b16 v[186:187], v240 offset:14848
    ds_read_b64_tr_b16 v[188:189], v241 offset:14336
    ds_read_b64_tr_b16 v[190:191], v241 offset:14848
    ds_read_b64_tr_b16 v[192:193], v240 offset:16384
    ds_read_b64_tr_b16 v[194:195], v240 offset:16896
    ds_read_b64_tr_b16 v[196:197], v241 offset:16384
    ds_read_b64_tr_b16 v[198:199], v241 offset:16896
    ds_read_b64_tr_b16 v[200:201], v240 offset:18432
    ds_read_b64_tr_b16 v[202:203], v240 offset:18944
    ds_read_b64_tr_b16 v[204:205], v241 offset:18432
    ds_read_b64_tr_b16 v[206:207], v241 offset:18944
    ds_read_b64_tr_b16 v[208:209], v240 offset:20480
    ds_read_b64_tr_b16 v[210:211], v240 offset:20992
    ds_read_b64_tr_b16 v[212:213], v241 offset:20480
    ds_read_b64_tr_b16 v[214:215], v241 offset:20992
    ds_read_b64_tr_b16 v[216:217], v240 offset:22528
    ds_read_b64_tr_b16 v[218:219], v240 offset:23040
    ds_read_b64_tr_b16 v[220:221], v241 offset:22528
    ds_read_b64_tr_b16 v[222:223], v241 offset:23040
    ds_read_b64_tr_b16 v[224:225], v240 offset:24576
    ds_read_b64_tr_b16 v[226:227], v240 offset:25088
    ds_read_b64_tr_b16 v[228:229], v241 offset:24576
    ds_read_b64_tr_b16 v[230:231], v241 offset:25088
    ds_read_b64_tr_b16 v[232:233], v240 offset:26624
    ds_read_b64_tr_b16 v[234:235], v240 offset:27136
    ds_read_b64_tr_b16 v[236:237], v241 offset:26624
    ds_read_b64_tr_b16 v[238:239], v241 offset:27136
    ds_read_b64 v[20:21], v254
    ds_read_b64 v[22:23], v254 offset:8448
    s_and_b32 s68, s61, 3
    s_lshr_b32 s69, s61, 2
    s_mul_i32 s69, s69, 7
    s_mul_i32 s3, s68, 28672
    s_lshl_b32 s71, s69, 11
    s_add_u32 s3, s3, s71
    s_mul_i32 s4, s68, 458752
    s_lshl_b32 s73, s85, 7
    s_add_u32 s4, s4, s73
    s_add_u32 s5, s69, 14
    s_waitcnt lgkmcnt(0)
    s_barrier
    ds_read_b128 v[32:35], v251 offset:0
    ds_read_b128 v[36:39], v251 offset:4096
    ds_read_b128 v[40:43], v251 offset:16384
    ds_read_b128 v[44:47], v255 offset:0
    s_add_u32 s6, s2, s5
    s_cmp_ge_u32 s6, 28
    s_cselect_b32 s7, 28, 0
    s_sub_u32 s6, s6, s7
    s_lshl_b32 s6, s6, 14
    s_add_u32 s6, s6, s4
    s_add_u32 m0, s3, 0
    s_add_u32 s5, s5, 1
    buffer_load_dwordx4 v243, s[48:51], s6 offen lds
    s_add_u32 m0, s3, 1024
    s_add_u32 s6, s6, 8192
    buffer_load_dwordx4 v243, s[48:51], s6 offen lds
    s_add_u32 s6, s2, s5
    s_cmp_ge_u32 s6, 28
    s_cselect_b32 s7, 28, 0
    s_sub_u32 s6, s6, s7
    s_lshl_b32 s6, s6, 14
    s_add_u32 s6, s6, s4
    s_add_u32 m0, s3, 2048
    s_add_u32 s5, s5, 1
    buffer_load_dwordx4 v243, s[48:51], s6 offen lds
    s_add_u32 m0, s3, 3072
    s_add_u32 s6, s6, 8192
    buffer_load_dwordx4 v243, s[48:51], s6 offen lds
    s_add_u32 s6, s2, s5
    s_cmp_ge_u32 s6, 28
    s_cselect_b32 s7, 28, 0
    s_sub_u32 s6, s6, s7
    s_lshl_b32 s6, s6, 14
    s_add_u32 s6, s6, s4
    s_add_u32 m0, s3, 4096
    s_add_u32 s5, s5, 1
    buffer_load_dwordx4 v243, s[48:51], s6 offen lds
    s_add_u32 m0, s3, 5120
    s_add_u32 s6, s6, 8192
    buffer_load_dwordx4 v243, s[48:51], s6 offen lds
    s_add_u32 s6, s2, s5
    s_cmp_ge_u32 s6, 28
    s_cselect_b32 s7, 28, 0
    s_sub_u32 s6, s6, s7
    s_lshl_b32 s6, s6, 14
    s_add_u32 s6, s6, s4
    s_add_u32 m0, s3, 6144
    s_add_u32 s5, s5, 1
    buffer_load_dwordx4 v243, s[48:51], s6 offen lds
    s_add_u32 m0, s3, 7168
    s_add_u32 s6, s6, 8192
    buffer_load_dwordx4 v243, s[48:51], s6 offen lds
    s_add_u32 s6, s2, s5
    s_cmp_ge_u32 s6, 28
    s_cselect_b32 s7, 28, 0
    s_sub_u32 s6, s6, s7
    s_lshl_b32 s6, s6, 14
    s_add_u32 s6, s6, s4
    s_add_u32 m0, s3, 8192
    s_add_u32 s5, s5, 1
    buffer_load_dwordx4 v243, s[48:51], s6 offen lds
    s_add_u32 m0, s3, 9216
    s_add_u32 s6, s6, 8192
    buffer_load_dwordx4 v243, s[48:51], s6 offen lds
    s_add_u32 s6, s2, s5
    s_cmp_ge_u32 s6, 28
    s_cselect_b32 s7, 28, 0
    s_sub_u32 s6, s6, s7
    s_lshl_b32 s6, s6, 14
    s_add_u32 s6, s6, s4
    s_add_u32 m0, s3, 10240
    s_add_u32 s5, s5, 1
    buffer_load_dwordx4 v243, s[48:51], s6 offen lds
    s_add_u32 m0, s3, 11264
    s_add_u32 s6, s6, 8192
    buffer_load_dwordx4 v243, s[48:51], s6 offen lds
    s_add_u32 s6, s2, s5
    s_cmp_ge_u32 s6, 28
    s_cselect_b32 s7, 28, 0
    s_sub_u32 s6, s6, s7
    s_lshl_b32 s6, s6, 14
    s_add_u32 s6, s6, s4
    s_add_u32 m0, s3, 12288
    s_add_u32 s5, s5, 1
    buffer_load_dwordx4 v243, s[48:51], s6 offen lds
    s_add_u32 m0, s3, 13312
    s_add_u32 s6, s6, 8192
    buffer_load_dwordx4 v243, s[48:51], s6 offen lds
    s_waitcnt lgkmcnt(0)
    v_add_f32 v24, v32, v36
    v_add_f32 v28, v40, v44
    v_add_f32 v25, v33, v37
    v_add_f32 v29, v41, v45
    v_add_f32 v26, v34, v38
    v_add_f32 v30, v42, v46
    v_add_f32 v27, v35, v39
    v_add_f32 v31, v43, v47
    v_and_b32 v10, 1, v1
    v_cmp_eq_u32 vcc, 0, v10
    v_mov_b32_dpp v48, v24 quad_perm:[1,0,3,2] row_mask:0xf bank_mask:0xf
    v_mov_b32_dpp v49, v25 quad_perm:[1,0,3,2] row_mask:0xf bank_mask:0xf
    v_mov_b32_dpp v50, v26 quad_perm:[1,0,3,2] row_mask:0xf bank_mask:0xf
    v_mov_b32_dpp v51, v27 quad_perm:[1,0,3,2] row_mask:0xf bank_mask:0xf
    v_cndmask_b32 v12,   v50, v24,   vcc
    v_cndmask_b32 v13, v26, v48,   vcc
    v_cndmask_b32 v14, v51, v25, vcc
    v_cndmask_b32 v15, v27, v49, vcc
    v_mov_b32_dpp v52, v28 quad_perm:[1,0,3,2] row_mask:0xf bank_mask:0xf
    v_mov_b32_dpp v53, v29 quad_perm:[1,0,3,2] row_mask:0xf bank_mask:0xf
    v_mov_b32_dpp v54, v30 quad_perm:[1,0,3,2] row_mask:0xf bank_mask:0xf
    v_mov_b32_dpp v55, v31 quad_perm:[1,0,3,2] row_mask:0xf bank_mask:0xf
    v_cndmask_b32 v16,   v54, v28,   vcc
    v_cndmask_b32 v17, v30, v52,   vcc
    v_cndmask_b32 v18, v55, v29, vcc
    v_cndmask_b32 v19, v31, v53, vcc
    v_readfirstlane_b32 s71, v249
    s_nop 0
    s_lshl_b32 s70, s71, 16
    s_and_b32 s71, s71, 0xffff0000
    v_and_b32 v32, 0xffff0000, v21
    v_lshlrev_b32 v33, 16, v21
    v_and_b32 v34, 0xffff0000, v20
    v_lshlrev_b32 v35, 16, v20
    v_mul_f32 v32, s70, v32
    v_mul_f32 v33, s70, v33
    v_mul_f32 v34, s70, v34
    v_mul_f32 v35, s70, v35
    v_cvt_pk_bf16_f32 v32, v32, v32
    v_lshlrev_b32 v32, 16, v32
    v_cvt_pk_bf16_f32 v12, v12, v12
    v_lshlrev_b32 v12, 16, v12
    v_cvt_pk_bf16_f32 v33, v33, v33
    v_lshlrev_b32 v33, 16, v33
    v_cvt_pk_bf16_f32 v13, v13, v13
    v_lshlrev_b32 v13, 16, v13
    v_cvt_pk_bf16_f32 v34, v34, v34
    v_lshlrev_b32 v34, 16, v34
    v_cvt_pk_bf16_f32 v14, v14, v14
    v_lshlrev_b32 v14, 16, v14
    v_cvt_pk_bf16_f32 v35, v35, v35
    v_lshlrev_b32 v35, 16, v35
    v_cvt_pk_bf16_f32 v15, v15, v15
    v_lshlrev_b32 v15, 16, v15
    v_add_f32 v12, v12, v32
    v_add_f32 v13, v13, v33
    v_add_f32 v14, v14, v34
    v_add_f32 v15, v15, v35
    v_and_b32 v36, 0xffff0000, v23
    v_lshlrev_b32 v37, 16, v23
    v_and_b32 v38, 0xffff0000, v22
    v_lshlrev_b32 v39, 16, v22
    v_mul_f32 v36, s71, v36
    v_mul_f32 v37, s71, v37
    v_mul_f32 v38, s71, v38
    v_mul_f32 v39, s71, v39
    v_cvt_pk_bf16_f32 v36, v36, v36
    v_lshlrev_b32 v36, 16, v36
    v_cvt_pk_bf16_f32 v16, v16, v16
    v_lshlrev_b32 v16, 16, v16
    v_cvt_pk_bf16_f32 v37, v37, v37
    v_lshlrev_b32 v37, 16, v37
    v_cvt_pk_bf16_f32 v17, v17, v17
    v_lshlrev_b32 v17, 16, v17
    v_cvt_pk_bf16_f32 v38, v38, v38
    v_lshlrev_b32 v38, 16, v38
    v_cvt_pk_bf16_f32 v18, v18, v18
    v_lshlrev_b32 v18, 16, v18
    v_cvt_pk_bf16_f32 v39, v39, v39
    v_lshlrev_b32 v39, 16, v39
    v_cvt_pk_bf16_f32 v19, v19, v19
    v_lshlrev_b32 v19, 16, v19
    v_add_f32 v16, v16, v36
    v_add_f32 v17, v17, v37
    v_add_f32 v18, v18, v38
    v_add_f32 v19, v19, v39
    v_cvt_pk_bf16_f32 v28, v12, v16
    v_cvt_pk_bf16_f32 v29, v13, v17
    v_cvt_pk_bf16_f32 v30, v14, v18
    v_cvt_pk_bf16_f32 v31, v15, v19
    s_lshl_b32 s70, s60, 13
    s_add_u32 s70, s70, 9437184
    buffer_store_dwordx4 v[28:31], v253, s[52:55], s70 offen sc1
    s_waitcnt vmcnt(0)
    s_lshl_b32 s68, s60, 7
    s_lshl_b32 s69, s26, 2
    s_add_u32 s68, s68, s69
    s_add_u32 s68, s68, 11698176
    v_mov_b32 v12, s67
    v_mov_b32 v13, 0
    s_mov_b64 s[82:83], exec
    s_mov_b64 exec, 1
    buffer_store_dword v12, v13, s[52:55], s68 offen sc1
    s_mov_b64 exec, s[82:83]
    v_cmp_ne_u32 vcc, s67, v9
    s_nop 4
    s_cbranch_vccz L_hf3_48
    s_mov_b32 s100, 0
    s_mov_b64 s[82:83], exec
L_pf_49:
    buffer_load_dword v9, v252, s[52:55], 0 offen sc1
    s_waitcnt vmcnt(0)
    v_cmp_ne_u32 vcc, s67, v9
    s_add_u32 s100, s100, 1
    s_nop 3
    s_cbranch_vccz L_pfx_50
    s_cmp_lt_u32 s100, 30000
    s_cbranch_scc1 L_pf_49
L_pfx_50:
    s_mov_b64 exec, s[82:83]
L_hf3_48:
    s_mul_i32 s78, s84, 229376
    s_and_b32 s68, s61, 3
    s_mul_i32 s68, s68, 57344
    s_add_u32 s78, s78, s68
    s_add_u32 s78, s78, 0
    s_add_u32 s77, s2, 0
    s_cmp_ge_u32 s77, 28
    s_cselect_b32 s79, 28, 0
    s_sub_u32 s77, s77, s79
    s_lshl_b32 s77, s77, 11
    s_add_u32 s77, s77, s78
    buffer_load_dwordx4 v[64:67], v242, s[52:55], s77 offen sc1
    s_add_u32 s77, s2, 1
    s_cmp_ge_u32 s77, 28
    s_cselect_b32 s79, 28, 0
    s_sub_u32 s77, s77, s79
    s_lshl_b32 s77, s77, 11
    s_add_u32 s77, s77, s78
    buffer_load_dwordx4 v[68:71], v242, s[52:55], s77 offen sc1
    s_add_u32 s77, s2, 2
    s_cmp_ge_u32 s77, 28
    s_cselect_b32 s79, 28, 0
    s_sub_u32 s77, s77, s79
    s_lshl_b32 s77, s77, 11
    s_add_u32 s77, s77, s78
    buffer_load_dwordx4 v[72:75], v242, s[52:55], s77 offen sc1
    s_add_u32 s77, s2, 3
    s_cmp_ge_u32 s77, 28
    s_cselect_b32 s79, 28, 0
    s_sub_u32 s77, s77, s79
    s_lshl_b32 s77, s77, 11
    s_add_u32 s77, s77, s78
    buffer_load_dwordx4 v[76:79], v242, s[52:55], s77 offen sc1
    s_add_u32 s77, s2, 4
    s_cmp_ge_u32 s77, 28
    s_cselect_b32 s79, 28, 0
    s_sub_u32 s77, s77, s79
    s_lshl_b32 s77, s77, 11
    s_add_u32 s77, s77, s78
    buffer_load_dwordx4 v[80:83], v242, s[52:55], s77 offen sc1
    s_add_u32 s77, s2, 5
    s_cmp_ge_u32 s77, 28
    s_cselect_b32 s79, 28, 0
    s_sub_u32 s77, s77, s79
    s_lshl_b32 s77, s77, 11
    s_add_u32 s77, s77, s78
    buffer_load_dwordx4 v[84:87], v242, s[52:55], s77 offen sc1
    s_add_u32 s77, s2, 6
    s_cmp_ge_u32 s77, 28
    s_cselect_b32 s79, 28, 0
    s_sub_u32 s77, s77, s79
    s_lshl_b32 s77, s77, 11
    s_add_u32 s77, s77, s78
    buffer_load_dwordx4 v[88:91], v242, s[52:55], s77 offen sc1
    s_waitcnt vmcnt(6)
    v_mfma_f32_32x32x16_bf16 v[96:111], v[128:131], v[64:67], 0
    s_add_u32 s77, s2, 7
    s_cmp_ge_u32 s77, 28
    s_cselect_b32 s79, 28, 0
    s_sub_u32 s77, s77, s79
    s_lshl_b32 s77, s77, 11
    s_add_u32 s77, s77, s78
    buffer_load_dwordx4 v[92:95], v242, s[52:55], s77 offen sc1
    v_mfma_f32_32x32x16_bf16 v[112:127], v[132:135], v[64:67], 0
    s_waitcnt vmcnt(6)
    v_mfma_f32_32x32x16_bf16 v[96:111], v[136:139], v[68:71], v[96:111]
    s_add_u32 s77, s2, 8
    s_cmp_ge_u32 s77, 28
    s_cselect_b32 s79, 28, 0
    s_sub_u32 s77, s77, s79
    s_lshl_b32 s77, s77, 11
    s_add_u32 s77, s77, s78
    buffer_load_dwordx4 v[64:67], v242, s[52:55], s77 offen sc1
    v_mfma_f32_32x32x16_bf16 v[112:127], v[140:143], v[68:71], v[112:127]
    s_waitcnt vmcnt(6)
    v_mfma_f32_32x32x16_bf16 v[96:111], v[144:147], v[72:75], v[96:111]
    s_add_u32 s77, s2, 9
    s_cmp_ge_u32 s77, 28
    s_cselect_b32 s79, 28, 0
    s_sub_u32 s77, s77, s79
    s_lshl_b32 s77, s77, 11
    s_add_u32 s77, s77, s78
    buffer_load_dwordx4 v[68:71], v242, s[52:55], s77 offen sc1
    v_mfma_f32_32x32x16_bf16 v[112:127], v[148:151], v[72:75], v[112:127]
    s_waitcnt vmcnt(6)
    v_mfma_f32_32x32x16_bf16 v[96:111], v[152:155], v[76:79], v[96:111]
    s_add_u32 s77, s2, 10
    s_cmp_ge_u32 s77, 28
    s_cselect_b32 s79, 28, 0
    s_sub_u32 s77, s77, s79
    s_lshl_b32 s77, s77, 11
    s_add_u32 s77, s77, s78
    buffer_load_dwordx4 v[72:75], v242, s[52:55], s77 offen sc1
    v_mfma_f32_32x32x16_bf16 v[112:127], v[156:159], v[76:79], v[112:127]
    s_waitcnt vmcnt(6)
    v_mfma_f32_32x32x16_bf16 v[96:111], v[160:163], v[80:83], v[96:111]
    s_add_u32 s77, s2, 11
    s_cmp_ge_u32 s77, 28
    s_cselect_b32 s79, 28, 0
    s_sub_u32 s77, s77, s79
    s_lshl_b32 s77, s77, 11
    s_add_u32 s77, s77, s78
    buffer_load_dwordx4 v[76:79], v242, s[52:55], s77 offen sc1
    v_mfma_f32_32x32x16_bf16 v[112:127], v[164:167], v[80:83], v[112:127]
    s_waitcnt vmcnt(6)
    v_mfma_f32_32x32x16_bf16 v[96:111], v[168:171], v[84:87], v[96:111]
    s_add_u32 s77, s2, 12
    s_cmp_ge_u32 s77, 28
    s_cselect_b32 s79, 28, 0
    s_sub_u32 s77, s77, s79
    s_lshl_b32 s77, s77, 11
    s_add_u32 s77, s77, s78
    buffer_load_dwordx4 v[80:83], v242, s[52:55], s77 offen sc1
    v_mfma_f32_32x32x16_bf16 v[112:127], v[172:175], v[84:87], v[112:127]
    s_waitcnt vmcnt(6)
    v_mfma_f32_32x32x16_bf16 v[96:111], v[176:179], v[88:91], v[96:111]
    s_add_u32 s77, s2, 13
    s_cmp_ge_u32 s77, 28
    s_cselect_b32 s79, 28, 0
    s_sub_u32 s77, s77, s79
    s_lshl_b32 s77, s77, 11
    s_add_u32 s77, s77, s78
    buffer_load_dwordx4 v[84:87], v242, s[52:55], s77 offen sc1
    v_mfma_f32_32x32x16_bf16 v[112:127], v[180:183], v[88:91], v[112:127]
    s_waitcnt vmcnt(6)
    v_mfma_f32_32x32x16_bf16 v[96:111], v[184:187], v[92:95], v[96:111]
    s_add_u32 s77, s2, 14
    s_cmp_ge_u32 s77, 28
    s_cselect_b32 s79, 28, 0
    s_sub_u32 s77, s77, s79
    s_lshl_b32 s77, s77, 11
    s_add_u32 s77, s77, s78
    buffer_load_dwordx4 v[88:91], v242, s[52:55], s77 offen sc1
    v_mfma_f32_32x32x16_bf16 v[112:127], v[188:191], v[92:95], v[112:127]
    s_waitcnt vmcnt(6)
    v_mfma_f32_32x32x16_bf16 v[96:111], v[192:195], v[64:67], v[96:111]
    s_add_u32 s77, s2, 15
    s_cmp_ge_u32 s77, 28
    s_cselect_b32 s79, 28, 0
    s_sub_u32 s77, s77, s79
    s_lshl_b32 s77, s77, 11
    s_add_u32 s77, s77, s78
    buffer_load_dwordx4 v[92:95], v242, s[52:55], s77 offen sc1
    v_mfma_f32_32x32x16_bf16 v[112:127], v[196:199], v[64:67], v[112:127]
    buffer_load_dwordx2 v[60:61], v244, s[40:43], s38 offen
    buffer_load_dwordx2 v[62:63], v244, s[40:43], s38 offen offset:64
    s_waitcnt vmcnt(8)
    v_mfma_f32_32x32x16_bf16 v[96:111], v[200:203], v[68:71], v[96:111]
    s_add_u32 s77, s2, 16
    s_cmp_ge_u32 s77, 28
    s_cselect_b32 s79, 28, 0
    s_sub_u32 s77, s77, s79
    s_lshl_b32 s77, s77, 11
    s_add_u32 s77, s77, s78
    buffer_load_dwordx4 v[64:67], v242, s[52:55], s77 offen sc1
    v_mfma_f32_32x32x16_bf16 v[112:127], v[204:207], v[68:71], v[112:127]
    s_waitcnt vmcnt(8)
    v_mfma_f32_32x32x16_bf16 v[96:111], v[208:211], v[72:75], v[96:111]
    s_add_u32 s77, s2, 17
    s_cmp_ge_u32 s77, 28
    s_cselect_b32 s79, 28, 0
    s_sub_u32 s77, s77, s79
    s_lshl_b32 s77, s77, 11
    s_add_u32 s77, s77, s78
    buffer_load_dwordx4 v[68:71], v242, s[52:55], s77 offen sc1
    v_mfma_f32_32x32x16_bf16 v[112:127], v[212:215], v[72:75], v[112:127]
    s_waitcnt vmcnt(8)
    v_mfma_f32_32x32x16_bf16 v[96:111], v[216:219], v[76:79], v[96:111]
    s_add_u32 s77, s2, 18
    s_cmp_ge_u32 s77, 28
    s_cselect_b32 s79, 28, 0
    s_sub_u32 s77, s77, s79
    s_lshl_b32 s77, s77, 11
    s_add_u32 s77, s77, s78
    buffer_load_dwordx4 v[72:75], v242, s[52:55], s77 offen sc1
    v_mfma_f32_32x32x16_bf16 v[112:127], v[220:223], v[76:79], v[112:127]
    s_waitcnt vmcnt(8)
    v_mfma_f32_32x32x16_bf16 v[96:111], v[224:227], v[80:83], v[96:111]
    s_add_u32 s77, s2, 19
    s_cmp_ge_u32 s77, 28
    s_cselect_b32 s79, 28, 0
    s_sub_u32 s77, s77, s79
    s_lshl_b32 s77, s77, 11
    s_add_u32 s77, s77, s78
    buffer_load_dwordx4 v[76:79], v242, s[52:55], s77 offen sc1
    v_mfma_f32_32x32x16_bf16 v[112:127], v[228:231], v[80:83], v[112:127]
    s_barrier
    s_waitcnt vmcnt(8)
    v_mfma_f32_32x32x16_bf16 v[96:111], v[232:235], v[84:87], v[96:111]
    ds_read_b64_tr_b16 v[40:41], v240 offset:0
    ds_read_b64_tr_b16 v[42:43], v240 offset:512
    ds_read_b64_tr_b16 v[44:45], v241 offset:0
    ds_read_b64_tr_b16 v[46:47], v241 offset:512
    s_add_u32 s77, s2, 20
    s_cmp_ge_u32 s77, 28
    s_cselect_b32 s79, 28, 0
    s_sub_u32 s77, s77, s79
    s_lshl_b32 s77, s77, 11
    s_add_u32 s77, s77, s78
    buffer_load_dwordx4 v[80:83], v242, s[52:55], s77 offen sc1
    v_mfma_f32_32x32x16_bf16 v[112:127], v[236:239], v[84:87], v[112:127]
    s_waitcnt lgkmcnt(0)
    s_waitcnt vmcnt(8)
    v_mfma_f32_32x32x16_bf16 v[96:111], v[40:43], v[88:91], v[96:111]
    ds_read_b64_tr_b16 v[48:49], v240 offset:2048
    ds_read_b64_tr_b16 v[50:51], v240 offset:2560
    ds_read_b64_tr_b16 v[52:53], v241 offset:2048
    ds_read_b64_tr_b16 v[54:55], v241 offset:2560
    s_add_u32 s77, s2, 21
    s_cmp_ge_u32 s77, 28
    s_cselect_b32 s79, 28, 0
    s_sub_u32 s77, s77, s79
    s_lshl_b32 s77, s77, 11
    s_add_u32 s77, s77, s78
    buffer_load_dwordx4 v[84:87], v242, s[52:55], s77 offen sc1
    v_mfma_f32_32x32x16_bf16 v[112:127], v[44:47], v[88:91], v[112:127]
    s_waitcnt lgkmcnt(0)
    s_waitcnt vmcnt(8)
    v_mfma_f32_32x32x16_bf16 v[96:111], v[48:51], v[92:95], v[96:111]
    ds_read_b64_tr_b16 v[40:41], v240 offset:4096
    ds_read_b64_tr_b16 v[42:43], v240 offset:4608
    ds_read_b64_tr_b16 v[44:45], v241 offset:4096
    ds_read_b64_tr_b16 v[46:47], v241 offset:4608
    s_add_u32 s77, s2, 22
    s_cmp_ge_u32 s77, 28
    s_cselect_b32 s79, 28, 0
    s_sub_u32 s77, s77, s79
    s_lshl_b32 s77, s77, 11
    s_add_u32 s77, s77, s78
    buffer_load_dwordx4 v[88:91], v242, s[52:55], s77 offen sc1
    v_mfma_f32_32x32x16_bf16 v[112:127], v[52:55], v[92:95], v[112:127]
    s_waitcnt lgkmcnt(0)
    s_waitcnt vmcnt(6)
    v_mfma_f32_32x32x16_bf16 v[96:111], v[40:43], v[64:67], v[96:111]
    ds_read_b64_tr_b16 v[48:49], v240 offset:6144
    ds_read_b64_tr_b16 v[50:51], v240 offset:6656
    ds_read_b64_tr_b16 v[52:53], v241 offset:6144
    ds_read_b64_tr_b16 v[54:55], v241 offset:6656
    s_add_u32 s77, s2, 23
    s_cmp_ge_u32 s77, 28
    s_cselect_b32 s79, 28, 0
    s_sub_u32 s77, s77, s79
    s_lshl_b32 s77, s77, 11
    s_add_u32 s77, s77, s78
    buffer_load_dwordx4 v[92:95], v242, s[52:55], s77 offen sc1
    v_mfma_f32_32x32x16_bf16 v[112:127], v[44:47], v[64:67], v[112:127]
    buffer_load_dword v8, v248, s[52:55], 0 offen sc1
    s_waitcnt lgkmcnt(0)
    s_waitcnt vmcnt(7)
    v_mfma_f32_32x32x16_bf16 v[96:111], v[48:51], v[68:71], v[96:111]
    ds_read_b64_tr_b16 v[40:41], v240 offset:8192
    ds_read_b64_tr_b16 v[42:43], v240 offset:8704
    ds_read_b64_tr_b16 v[44:45], v241 offset:8192
    ds_read_b64_tr_b16 v[46:47], v241 offset:8704
    s_add_u32 s77, s2, 24
    s_cmp_ge_u32 s77, 28
    s_cselect_b32 s79, 28, 0
    s_sub_u32 s77, s77, s79
    s_lshl_b32 s77, s77, 11
    s_add_u32 s77, s77, s78
    buffer_load_dwordx4 v[64:67], v242, s[52:55], s77 offen sc1
    v_mfma_f32_32x32x16_bf16 v[112:127], v[52:55], v[68:71], v[112:127]
    s_waitcnt lgkmcnt(0)
    s_waitcnt vmcnt(7)
    v_mfma_f32_32x32x16_bf16 v[96:111], v[40:43], v[72:75], v[96:111]
    ds_read_b64_tr_b16 v[48:49], v240 offset:10240
    ds_read_b64_tr_b16 v[50:51], v240 offset:10752
    ds_read_b64_tr_b16 v[52:53], v241 offset:10240
    ds_read_b64_tr_b16 v[54:55], v241 offset:10752
    s_add_u32 s77, s2, 25
    s_cmp_ge_u32 s77, 28
    s_cselect_b32 s79, 28, 0
    s_sub_u32 s77, s77, s79
    s_lshl_b32 s77, s77, 11
    s_add_u32 s77, s77, s78
    buffer_load_dwordx4 v[68:71], v242, s[52:55], s77 offen sc1
    v_mfma_f32_32x32x16_bf16 v[112:127], v[44:47], v[72:75], v[112:127]
    s_waitcnt lgkmcnt(0)
    s_waitcnt vmcnt(7)
    v_mfma_f32_32x32x16_bf16 v[96:111], v[48:51], v[76:79], v[96:111]
    ds_read_b64_tr_b16 v[40:41], v240 offset:12288
    ds_read_b64_tr_b16 v[42:43], v240 offset:12800
    ds_read_b64_tr_b16 v[44:45], v241 offset:12288
    ds_read_b64_tr_b16 v[46:47], v241 offset:12800
    s_add_u32 s77, s2, 26
    s_cmp_ge_u32 s77, 28
    s_cselect_b32 s79, 28, 0
    s_sub_u32 s77, s77, s79
    s_lshl_b32 s77, s77, 11
    s_add_u32 s77, s77, s78
    buffer_load_dwordx4 v[72:75], v242, s[52:55], s77 offen sc1
    v_mfma_f32_32x32x16_bf16 v[112:127], v[52:55], v[76:79], v[112:127]
    s_waitcnt lgkmcnt(0)
    s_waitcnt vmcnt(7)
    v_mfma_f32_32x32x16_bf16 v[96:111], v[40:43], v[80:83], v[96:111]
    ds_read_b64_tr_b16 v[48:49], v240 offset:14336
    ds_read_b64_tr_b16 v[50:51], v240 offset:14848
    ds_read_b64_tr_b16 v[52:53], v241 offset:14336
    ds_read_b64_tr_b16 v[54:55], v241 offset:14848
    s_add_u32 s77, s2, 27
    s_cmp_ge_u32 s77, 28
    s_cselect_b32 s79, 28, 0
    s_sub_u32 s77, s77, s79
    s_lshl_b32 s77, s77, 11
    s_add_u32 s77, s77, s78
    buffer_load_dwordx4 v[76:79], v242, s[52:55], s77 offen sc1
    v_mfma_f32_32x32x16_bf16 v[112:127], v[44:47], v[80:83], v[112:127]
    s_waitcnt lgkmcnt(0)
    s_waitcnt vmcnt(7)
    v_mfma_f32_32x32x16_bf16 v[96:111], v[48:51], v[84:87], v[96:111]
    ds_read_b64_tr_b16 v[40:41], v240 offset:16384
    ds_read_b64_tr_b16 v[42:43], v240 offset:16896
    ds_read_b64_tr_b16 v[44:45], v241 offset:16384
    ds_read_b64_tr_b16 v[46:47], v241 offset:16896
    v_mfma_f32_32x32x16_bf16 v[112:127], v[52:55], v[84:87], v[112:127]
    s_waitcnt vmcnt(4)
    v_cmp_ne_u32 vcc, s67, v8
    s_nop 4
    s_cbranch_vccz L_sf_51
    s_mov_b32 s100, 0
    s_mov_b64 s[82:83], exec
L_pf_52:
    buffer_load_dword v8, v248, s[52:55], 0 offen sc1
    s_waitcnt vmcnt(0)
    v_cmp_ne_u32 vcc, s67, v8
    s_add_u32 s100, s100, 1
    s_nop 3
    s_cbranch_vccz L_pfx_53
    s_cmp_lt_u32 s100, 30000
    s_cbranch_scc1 L_pf_52
L_pfx_53:
    s_mov_b64 exec, s[82:83]
L_sf_51:
    s_add_u32 s73, s39, 0
    buffer_load_dword v56, v245, s[52:55], s73 offen sc1
    s_add_u32 s73, s39, 8192
    buffer_load_dword v57, v245, s[52:55], s73 offen sc1
    s_add_u32 s73, s39, 131072
    buffer_load_dword v58, v245, s[52:55], s73 offen sc1
    s_add_u32 s73, s39, 139264
    buffer_load_dword v59, v245, s[52:55], s73 offen sc1
    s_waitcnt lgkmcnt(0)
    v_mfma_f32_32x32x16_bf16 v[96:111], v[40:43], v[88:91], v[96:111]
    ds_read_b64_tr_b16 v[48:49], v240 offset:18432
    ds_read_b64_tr_b16 v[50:51], v240 offset:18944
    ds_read_b64_tr_b16 v[52:53], v241 offset:18432
    ds_read_b64_tr_b16 v[54:55], v241 offset:18944
    v_mfma_f32_32x32x16_bf16 v[112:127], v[44:47], v[88:91], v[112:127]
    s_waitcnt lgkmcnt(0)
    v_mfma_f32_32x32x16_bf16 v[96:111], v[48:51], v[92:95], v[96:111]
    ds_read_b64_tr_b16 v[40:41], v240 offset:20480
    ds_read_b64_tr_b16 v[42:43], v240 offset:20992
    ds_read_b64_tr_b16 v[44:45], v241 offset:20480
    ds_read_b64_tr_b16 v[46:47], v241 offset:20992
    v_mfma_f32_32x32x16_bf16 v[112:127], v[52:55], v[92:95], v[112:127]
    s_waitcnt lgkmcnt(0)
    s_waitcnt vmcnt(7)
    v_mfma_f32_32x32x16_bf16 v[96:111], v[40:43], v[64:67], v[96:111]
    ds_read_b64_tr_b16 v[48:49], v240 offset:22528
    ds_read_b64_tr_b16 v[50:51], v240 offset:23040
    ds_read_b64_tr_b16 v[52:53], v241 offset:22528
    ds_read_b64_tr_b16 v[54:55], v241 offset:23040
    v_mfma_f32_32x32x16_bf16 v[112:127], v[44:47], v[64:67], v[112:127]
    s_waitcnt lgkmcnt(0)
    s_waitcnt vmcnt(6)
    v_mfma_f32_32x32x16_bf16 v[96:111], v[48:51], v[68:71], v[96:111]
    ds_read_b64_tr_b16 v[40:41], v240 offset:24576
    ds_read_b64_tr_b16 v[42:43], v240 offset:25088
    ds_read_b64_tr_b16 v[44:45], v241 offset:24576
    ds_read_b64_tr_b16 v[46:47], v241 offset:25088
    v_mfma_f32_32x32x16_bf16 v[112:127], v[52:55], v[68:71], v[112:127]
    s_waitcnt lgkmcnt(0)
    s_waitcnt vmcnt(5)
    v_mfma_f32_32x32x16_bf16 v[96:111], v[40:43], v[72:75], v[96:111]
    ds_read_b64_tr_b16 v[48:49], v240 offset:26624
    ds_read_b64_tr_b16 v[50:51], v240 offset:27136
    ds_read_b64_tr_b16 v[52:53], v241 offset:26624
    ds_read_b64_tr_b16 v[54:55], v241 offset:27136
    v_mfma_f32_32x32x16_bf16 v[112:127], v[44:47], v[72:75], v[112:127]
    s_waitcnt lgkmcnt(0)
    s_waitcnt vmcnt(4)
    v_mfma_f32_32x32x16_bf16 v[96:111], v[48:51], v[76:79], v[96:111]
    v_mfma_f32_32x32x16_bf16 v[112:127], v[52:55], v[76:79], v[112:127]
    s_waitcnt vmcnt(0)
    v_lshlrev_b32 v16, 16, v56
    v_and_b32 v17, 0xffff0000, v56
    v_lshlrev_b32 v24, 16, v60
    v_and_b32 v25, 0xffff0000, v60
    v_lshlrev_b32 v18, 16, v57
    v_and_b32 v19, 0xffff0000, v57
    v_lshlrev_b32 v26, 16, v61
    v_and_b32 v27, 0xffff0000, v61
    v_lshlrev_b32 v20, 16, v58
    v_and_b32 v21, 0xffff0000, v58
    v_lshlrev_b32 v28, 16, v62
    v_and_b32 v29, 0xffff0000, v62
    v_lshlrev_b32 v22, 16, v59
    v_and_b32 v23, 0xffff0000, v59
    v_lshlrev_b32 v30, 16, v63
    v_and_b32 v31, 0xffff0000, v63
    v_lshlrev_b32 v14, 4, v1
    s_mul_i32 s72, s61, 6144
    s_add_u32 s72, s72, 114688
    v_add_u32 v15, s72, v14
    s_lshr_b32 s68, s61, 2
    s_mul_i32 s72, s68, 24576
    s_add_u32 s72, s72, 114688
    v_add_u32 v14, s72, v14
    s_and_b32 s69, s61, 3
    s_cmp_eq_u32 s69, 1
    s_cbranch_scc1 L_rq_56
    s_cmp_eq_u32 s69, 2
    s_cbranch_scc1 L_rq_57
    s_cmp_eq_u32 s69, 3
    s_cbranch_scc1 L_rq_58
L_rq_55:
    ds_write_b128 v15, v[100:103] offset:0
    ds_write_b128 v15, v[116:119] offset:1024
    ds_write_b128 v15, v[104:107] offset:2048
    ds_write_b128 v15, v[120:123] offset:3072
    ds_write_b128 v15, v[108:111] offset:4096
    ds_write_b128 v15, v[124:127] offset:5120
    v_mov_b32 v64, v96
    v_mov_b32 v65, v97
    v_mov_b32 v66, v98
    v_mov_b32 v67, v99
    v_mov_b32 v68, v112
    v_mov_b32 v69, v113
    v_mov_b32 v70, v114
    v_mov_b32 v71, v115
    s_waitcnt lgkmcnt(0)
    s_barrier
    ds_read_b128 v[72:75], v14 offset:6144
    ds_read_b128 v[76:79], v14 offset:7168
    ds_read_b128 v[80:83], v14 offset:12288
    ds_read_b128 v[84:87], v14 offset:13312
    ds_read_b128 v[88:91], v14 offset:18432
    ds_read_b128 v[92:95], v14 offset:19456
    s_branch L_red_54
L_rq_56:
    ds_write_b128 v15, v[96:99] offset:0
    ds_write_b128 v15, v[112:115] offset:1024
    ds_write_b128 v15, v[104:107] offset:2048
    ds_write_b128 v15, v[120:123] offset:3072
    ds_write_b128 v15, v[108:111] offset:4096
    ds_write_b128 v15, v[124:127] offset:5120
    v_mov_b32 v64, v100
    v_mov_b32 v65, v101
    v_mov_b32 v66, v102
    v_mov_b32 v67, v103
    v_mov_b32 v68, v116
    v_mov_b32 v69, v117
    v_mov_b32 v70, v118
    v_mov_b32 v71, v119
    s_waitcnt lgkmcnt(0)
    s_barrier
    ds_read_b128 v[72:75], v14 offset:0
    ds_read_b128 v[76:79], v14 offset:1024
    ds_read_b128 v[80:83], v14 offset:14336
    ds_read_b128 v[84:87], v14 offset:15360
    ds_read_b128 v[88:91], v14 offset:20480
    ds_read_b128 v[92:95], v14 offset:21504
    s_branch L_red_54
L_rq_57:
    ds_write_b128 v15, v[96:99] offset:0
    ds_write_b128 v15, v[112:115] offset:1024
    ds_write_b128 v15, v[100:103] offset:2048
    ds_write_b128 v15, v[116:119] offset:3072
    ds_write_b128 v15, v[108:111] offset:4096
    ds_write_b128 v15, v[124:127] offset:5120
    v_mov_b32 v64, v104
    v_mov_b32 v65, v105
    v_mov_b32 v66, v106
    v_mov_b32 v67, v107
    v_mov_b32 v68, v120
    v_mov_b32 v69, v121
    v_mov_b32 v70, v122
    v_mov_b32 v71, v123
    s_waitcnt lgkmcnt(0)
    s_barrier
    ds_read_b128 v[72:75], v14 offset:2048
    ds_read_b128 v[76:79], v14 offset:3072
    ds_read_b128 v[80:83], v14 offset:8192
    ds_read_b128 v[84:87], v14 offset:9216
    ds_read_b128 v[88:91], v14 offset:22528
    ds_read_b128 v[92:95], v14 offset:23552
    s_branch L_red_54
L_rq_58:
    ds_write_b128 v15, v[96:99] offset:0
    ds_write_b128 v15, v[112:115] offset:1024
    ds_write_b128 v15, v[100:103] offset:2048
    ds_write_b128 v15, v[116:119] offset:3072
    ds_write_b128 v15, v[104:107] offset:4096
    ds_write_b128 v15, v[120:123] offset:5120
    v_mov_b32 v64, v108
    v_mov_b32 v65, v109
    v_mov_b32 v66, v110
    v_mov_b32 v67, v111
    v_mov_b32 v68, v124
    v_mov_b32 v69, v125
    v_mov_b32 v70, v126
    v_mov_b32 v71, v127
    s_waitcnt lgkmcnt(0)
    s_barrier
    ds_read_b128 v[72:75], v14 offset:4096
    ds_read_b128 v[76:79], v14 offset:5120
    ds_read_b128 v[80:83], v14 offset:10240
    ds_read_b128 v[84:87], v14 offset:11264
    ds_read_b128 v[88:91], v14 offset:16384
    ds_read_b128 v[92:95], v14 offset:17408
L_red_54:
    s_waitcnt lgkmcnt(0)
    v_add_f32 v64, v64, v72
    v_add_f32 v80, v80, v88
    v_add_f32 v65, v65, v73
    v_add_f32 v81, v81, v89
    v_add_f32 v66, v66, v74
    v_add_f32 v82, v82, v90
    v_add_f32 v67, v67, v75
    v_add_f32 v83, v83, v91
    v_add_f32 v68, v68, v76
    v_add_f32 v84, v84, v92
    v_add_f32 v69, v69, v77
    v_add_f32 v85, v85, v93
    v_add_f32 v70, v70, v78
    v_add_f32 v86, v86, v94
    v_add_f32 v71, v71, v79
    v_add_f32 v87, v87, v95
    v_add_f32 v64, v64, v80
    v_add_f32 v65, v65, v81
    v_add_f32 v66, v66, v82
    v_add_f32 v67, v67, v83
    v_add_f32 v68, v68, v84
    v_add_f32 v69, v69, v85
    v_add_f32 v70, v70, v86
    v_add_f32 v71, v71, v87
    v_mul_f32 v64, 0xbf317218, v64
    v_mul_f32 v65, 0xbf317218, v65
    v_cvt_pk_bf16_f32 v72, v64, v65
    v_mul_f32 v66, 0xbf317218, v66
    v_mul_f32 v67, 0xbf317218, v67
    v_cvt_pk_bf16_f32 v74, v66, v67
    v_mul_f32 v68, 0xbf317218, v68
    v_mul_f32 v69, 0xbf317218, v69
    v_cvt_pk_bf16_f32 v76, v68, v69
    v_mul_f32 v70, 0xbf317218, v70
    v_mul_f32 v71, 0xbf317218, v71
    v_cvt_pk_bf16_f32 v78, v70, v71
    v_lshlrev_b32 v64, 16, v72
    v_and_b32 v65, 0xffff0000, v72
    v_lshlrev_b32 v66, 16, v74
    v_and_b32 v67, 0xffff0000, v74
    v_lshlrev_b32 v68, 16, v76
    v_and_b32 v69, 0xffff0000, v76
    v_lshlrev_b32 v70, 16, v78
    v_and_b32 v71, 0xffff0000, v78
    v_mul_f32 v72, 0xbfb8aa3b, v64
    v_mul_f32 v73, 0xbfb8aa3b, v65
    v_mul_f32 v74, 0xbfb8aa3b, v66
    v_mul_f32 v75, 0xbfb8aa3b, v67
    v_mul_f32 v76, 0xbfb8aa3b, v68
    v_mul_f32 v77, 0xbfb8aa3b, v69
    v_mul_f32 v78, 0xbfb8aa3b, v70
    v_mul_f32 v79, 0xbfb8aa3b, v71
    v_exp_f32 v72, v72
    v_exp_f32 v73, v73
    v_exp_f32 v74, v74
    v_exp_f32 v75, v75
    v_exp_f32 v76, v76
    v_exp_f32 v77, v77
    v_exp_f32 v78, v78
    v_exp_f32 v79, v79
    v_add_f32 v72, 1.0, v72
    v_add_f32 v73, 1.0, v73
    v_add_f32 v74, 1.0, v74
    v_add_f32 v75, 1.0, v75
    v_add_f32 v76, 1.0, v76
    v_add_f32 v77, 1.0, v77
    v_add_f32 v78, 1.0, v78
    v_add_f32 v79, 1.0, v79
    v_rcp_f32 v72, v72
    v_rcp_f32 v73, v73
    v_rcp_f32 v74, v74
    v_rcp_f32 v75, v75
    v_rcp_f32 v76, v76
    v_rcp_f32 v77, v77
    v_rcp_f32 v78, v78
    v_rcp_f32 v79, v79
    v_mul_f32 v64, v64, v72
    v_mul_f32 v65, v65, v73
    v_mul_f32 v66, v66, v74
    v_mul_f32 v67, v67, v75
    v_mul_f32 v68, v68, v76
    v_mul_f32 v69, v69, v77
    v_mul_f32 v70, v70, v78
    v_mul_f32 v71, v71, v79
    v_cvt_pk_bf16_f32 v72, v64, v65
    v_cvt_pk_bf16_f32 v74, v66, v67
    v_cvt_pk_bf16_f32 v76, v68, v69
    v_cvt_pk_bf16_f32 v78, v70, v71
    v_lshlrev_b32 v64, 16, v72
    v_and_b32 v65, 0xffff0000, v72
    v_lshlrev_b32 v66, 16, v74
    v_and_b32 v67, 0xffff0000, v74
    v_lshlrev_b32 v68, 16, v76
    v_and_b32 v69, 0xffff0000, v76
    v_lshlrev_b32 v70, 16, v78
    v_and_b32 v71, 0xffff0000, v78
    v_mul_f32 v64, v64, v16
    v_mul_f32 v65, v65, v17
    v_mul_f32 v66, v66, v18
    v_mul_f32 v67, v67, v19
    v_mul_f32 v68, v68, v20
    v_mul_f32 v69, v69, v21
    v_mul_f32 v70, v70, v22
    v_mul_f32 v71, v71, v23
    v_cvt_pk_bf16_f32 v72, v64, v65
    v_cvt_pk_bf16_f32 v74, v66, v67
    v_cvt_pk_bf16_f32 v76, v68, v69
    v_cvt_pk_bf16_f32 v78, v70, v71
    v_lshlrev_b32 v64, 16, v72
    v_and_b32 v65, 0xffff0000, v72
    v_lshlrev_b32 v66, 16, v74
    v_and_b32 v67, 0xffff0000, v74
    v_lshlrev_b32 v68, 16, v76
    v_and_b32 v69, 0xffff0000, v76
    v_lshlrev_b32 v70, 16, v78
    v_and_b32 v71, 0xffff0000, v78
    v_add_f32 v64, v64, v24
    v_add_f32 v65, v65, v25
    v_add_f32 v66, v66, v26
    v_add_f32 v67, v67, v27
    v_add_f32 v68, v68, v28
    v_add_f32 v69, v69, v29
    v_add_f32 v70, v70, v30
    v_add_f32 v71, v71, v31
    v_cvt_pk_bf16_f32 v32, v64, v65
    v_cvt_pk_bf16_f32 v33, v66, v67
    v_cvt_pk_bf16_f32 v34, v68, v69
    v_cvt_pk_bf16_f32 v35, v70, v71
    buffer_store_dwordx2 v[32:33], v244, s[56:59], s38 offen
    buffer_store_dwordx2 v[34:35], v244, s[56:59], s38 offen offset:64
    s_waitcnt vmcnt(0)
L_end:
    s_endpgm

.section .rodata,"a"
.p2align 6
.amdhsa_kernel recurrent_scan__ssm_conv_s4__dense_activation_silu__prompt_kernel
  .amdhsa_next_free_vgpr 256
  .amdhsa_next_free_sgpr 102
  .amdhsa_accum_offset 256
  .amdhsa_group_segment_fixed_size 0
  .amdhsa_kernarg_size 120
  .amdhsa_user_sgpr_count 2
  .amdhsa_user_sgpr_kernarg_segment_ptr 1
  .amdhsa_system_sgpr_workgroup_id_x 1
.end_amdhsa_kernel
```
